```python
import torch

def _softmax(x, axis=-1):
    return torch.softmax(x, dim=axis)
def _gelu(x):
    return torch.nn.functional.gelu(x, approximate="tanh")
def _silu(x):
    return torch.nn.functional.silu(x)
def _sigmoid(x):
    return torch.sigmoid(x)
def _layernorm(x, axis=-1, eps=1e-5):
    m = x.mean(dim=axis, keepdim=True)
    v = x.var(dim=axis, keepdim=True, unbiased=False)
    return (x - m) / torch.sqrt(v + eps)
def _scatter_add(tgt, idx, src, axis=0):
    return tgt.clone().index_add_(axis, idx, src)
def _segment_sum(src, seg, n):
    out = torch.zeros((n,) + src.shape[1:], dtype=src.dtype)
    return out.index_add_(0, seg, src)
def _pad(x, pw):
    flat = tuple(v for pair in reversed(pw) for v in pair)
    return torch.nn.functional.pad(x, flat)

kernel_name = 'standalone__dense_activation_squared_relu__prompt'

def setup_inputs():

    _w = (lambda a: (lambda t: t.to(torch.bfloat16) if t.is_floating_point() else t)(torch.as_tensor(a)))
    B, S, D, F = 1, 2048, 1024, 3584
    return {
        "x": _w((lambda *s: torch.randn(*s, dtype=torch.bfloat16) * 0.05)(B, S, D)),
        "w1": _w((lambda *s: torch.randn(*s, dtype=torch.bfloat16) * 0.05)(D, F)),
        "b1": _w((lambda *s: torch.randn(*s, dtype=torch.bfloat16) * 0.05)(F)),
        "w2": _w((lambda *s: torch.randn(*s, dtype=torch.bfloat16) * 0.05)(F, D)),
        "b2": _w((lambda *s: torch.randn(*s, dtype=torch.bfloat16) * 0.05)(D)),
    }

def reference(x, w1, b1, w2, b2):
    h = torch.einsum("bsd,df->bsf", x, w1) + b1
    zero = torch.zeros_like(h)
    r = torch.where(h > zero, h, zero)
    h = r * r
    out = torch.einsum("bsf,fd->bsd", h, w2) + b2
    return out
```

```asm
; @launch grid=(256,1,1) block=(512,1,1) lds=163840
.amdgcn_target "amdgcn-amd-amdhsa--gfx950"
.text
.globl standalone__dense_activation_squared_relu__prompt_kernel
.p2align 8
.type standalone__dense_activation_squared_relu__prompt_kernel,@function
standalone__dense_activation_squared_relu__prompt_kernel:
    s_cmp_ge_u32 s2, 256
    s_cbranch_scc1 L_end
    s_load_dwordx16 s[4:19], s[0:1], 0
    v_lshrrev_b32 v1, 6, v0
    v_and_b32 v0, 63, v0
    s_and_b32 s44, s2, 7
    s_lshr_b32 s45, s2, 3
    v_readfirstlane_b32 s3, v1
    s_and_b32 s40, s44, 1
    s_lshl_b32 s40, s40, 3
    s_and_b32 s46, s45, 7
    s_add_u32 s40, s40, s46
    s_lshr_b32 s41, s44, 1
    s_lshl_b32 s41, s41, 2
    s_lshr_b32 s46, s45, 3
    s_add_u32 s41, s41, s46
    s_lshr_b32 s42, s41, 3
    s_and_b32 s43, s41, 7
    s_mul_i32 s47, s41, 448
    s_cmp_lt_u32 s3, 4
    s_cbranch_scc1 L_cons
    s_sub_u32 s48, s3, 4
    s_movk_i32 s50, 2341
    s_movk_i32 s51, 7168
    s_mul_i32 s49, s48, 114688
    s_add_u32 s49, s49, s47
    v_add_u32 v1, 0, v0
    v_mul_u32_u24 v2, s50, v1
    v_lshrrev_b32 v2, 16, v2
    v_mul_u32_u24 v3, 28, v2
    v_sub_u32 v3, v1, v3
    v_lshrrev_b32 v4, 2, v2
    v_and_b32 v4, 2, v4
    v_xor_b32 v3, v3, v4
    v_lshlrev_b32 v3, 4, v3
    v_mad_u32_u24 v3, v2, s51, v3
    v_add_u32 v14, s49, v3
    v_add_u32 v1, 64, v0
    v_mul_u32_u24 v2, s50, v1
    v_lshrrev_b32 v2, 16, v2
    v_mul_u32_u24 v3, 28, v2
    v_sub_u32 v3, v1, v3
    v_lshrrev_b32 v4, 2, v2
    v_and_b32 v4, 2, v4
    v_xor_b32 v3, v3, v4
    v_lshlrev_b32 v3, 4, v3
    v_mad_u32_u24 v3, v2, s51, v3
    v_add_u32 v15, s49, v3
    v_add_u32 v1, 128, v0
    v_mul_u32_u24 v2, s50, v1
    v_lshrrev_b32 v2, 16, v2
    v_mul_u32_u24 v3, 28, v2
    v_sub_u32 v3, v1, v3
    v_lshrrev_b32 v4, 2, v2
    v_and_b32 v4, 2, v4
    v_xor_b32 v3, v3, v4
    v_lshlrev_b32 v3, 4, v3
    v_mad_u32_u24 v3, v2, s51, v3
    v_add_u32 v16, s49, v3
    v_add_u32 v1, 192, v0
    v_mul_u32_u24 v2, s50, v1
    v_lshrrev_b32 v2, 16, v2
    v_mul_u32_u24 v3, 28, v2
    v_sub_u32 v3, v1, v3
    v_lshrrev_b32 v4, 2, v2
    v_and_b32 v4, 2, v4
    v_xor_b32 v3, v3, v4
    v_lshlrev_b32 v3, 4, v3
    v_mad_u32_u24 v3, v2, s51, v3
    v_add_u32 v17, s49, v3
    v_add_u32 v1, 256, v0
    v_mul_u32_u24 v2, s50, v1
    v_lshrrev_b32 v2, 16, v2
    v_mul_u32_u24 v3, 28, v2
    v_sub_u32 v3, v1, v3
    v_lshrrev_b32 v4, 2, v2
    v_and_b32 v4, 2, v4
    v_xor_b32 v3, v3, v4
    v_lshlrev_b32 v3, 4, v3
    v_mad_u32_u24 v3, v2, s51, v3
    v_add_u32 v18, s49, v3
    v_add_u32 v1, 320, v0
    v_mul_u32_u24 v2, s50, v1
    v_lshrrev_b32 v2, 16, v2
    v_mul_u32_u24 v3, 28, v2
    v_sub_u32 v3, v1, v3
    v_lshrrev_b32 v4, 2, v2
    v_and_b32 v4, 2, v4
    v_xor_b32 v3, v3, v4
    v_lshlrev_b32 v3, 4, v3
    v_mad_u32_u24 v3, v2, s51, v3
    v_add_u32 v19, s49, v3
    v_add_u32 v1, 384, v0
    v_mul_u32_u24 v2, s50, v1
    v_lshrrev_b32 v2, 16, v2
    v_mul_u32_u24 v3, 28, v2
    v_sub_u32 v3, v1, v3
    v_lshrrev_b32 v4, 2, v2
    v_and_b32 v4, 2, v4
    v_xor_b32 v3, v3, v4
    v_lshlrev_b32 v3, 4, v3
    v_mad_u32_u24 v3, v2, s51, v3
    v_add_u32 v20, s49, v3
    s_lshl_b32 s49, s40, 18
    s_lshl_b32 s50, s48, 16
    s_add_u32 s49, s49, s50
    v_lshrrev_b32 v5, 3, v0
    v_lshlrev_b32 v5, 11, v5
    v_add_u32 v1, s49, v5
    v_and_b32 v6, 7, v0
    v_lshrrev_b32 v7, 4, v0
    v_xor_b32 v2, v6, v7
    v_lshlrev_b32 v2, 4, v2
    v_add_u32 v10, v1, v2
    v_xor_b32 v3, 64, v2
    v_add_u32 v11, v1, v3
    v_add_u32 v11, 16384, v11
    v_add_u32 v12, v1, v2
    v_add_u32 v12, 32768, v12
    v_xor_b32 v3, 64, v2
    v_add_u32 v13, v1, v3
    v_add_u32 v13, 49152, v13
    s_lshr_b32 s52, s41, 2
    s_lshr_b32 s53, s40, 3
    s_lshl_b32 s53, s53, 1
    s_add_u32 s52, s52, s53
    s_and_b32 s53, s40, 1
    s_add_u32 s52, s52, s53
    s_and_b32 s52, s52, 3
    s_mul_i32 s53, s52, 1835008
    s_lshl_b32 s52, s52, 9
    s_lshl_b32 s54, s48, 12
    s_mul_i32 s55, s48, 7168
    s_add_u32 s55, s55, 16384
    s_mov_b32 s56, 45056
    s_mov_b32 s57, 0
    s_mul_i32 s58, s42, 1792
    s_mul_i32 s59, s40, 112
    s_add_u32 s58, s58, s59
    s_and_b32 s59, s41, 3
    s_mul_i32 s59, s59, 28
    s_add_u32 s58, s58, s59
    s_mul_i32 s59, s48, 7
    s_add_u32 s58, s58, s59
    s_lshl_b32 s58, s58, 11
    s_and_b32 s59, s41, 4
    s_lshl_b32 s59, s59, 8
    s_add_u32 s58, s58, s59
    s_waitcnt lgkmcnt(0)
    s_mov_b32 s20, s4
    s_mov_b32 s21, s5
    s_mov_b32 s22, 0x400000
    s_mov_b32 s23, 0x20000
    s_mov_b32 s24, s6
    s_mov_b32 s25, s7
    s_mov_b32 s26, 0x700000
    s_mov_b32 s27, 0x20000
    s_add_u32 s58, s10, s58
    s_addc_u32 s59, s11, 0
    s_movk_i32 s60, 512
    s_lshl_b32 s61, s40, 4
    s_add_u32 s61, s61, s41
    s_lshl_b32 s61, s61, 11
    s_mul_i32 s62, s48, 384
    s_add_u32 s61, s61, s62
    s_add_u32 s61, s61, 0x1600000
    s_add_u32 s28, s18, s61
    s_addc_u32 s29, s19, 0
    s_load_dword s63, s[28:29], 0
    s_load_dword s63, s[28:29], 64
    s_load_dword s63, s[28:29], 128
    s_load_dword s63, s[28:29], 192
    s_load_dword s63, s[28:29], 256
    s_load_dword s63, s[28:29], 320
P_loop:
    s_cmp_lt_u32 s57, 3
    s_cbranch_scc1 P_issue
    s_waitcnt vmcnt(11)
    s_barrier
P_issue:
    s_add_u32 s61, s56, s55
    s_add_u32 s62, s56, s54
    s_add_u32 m0, s61, 0
    s_nop 0
    buffer_load_dwordx4 v14, s[24:27], s53 offen lds
    s_add_u32 m0, s61, 1024
    s_nop 0
    buffer_load_dwordx4 v15, s[24:27], s53 offen lds
    s_add_u32 m0, s61, 2048
    s_nop 0
    buffer_load_dwordx4 v16, s[24:27], s53 offen lds
    s_add_u32 m0, s61, 3072
    s_nop 0
    buffer_load_dwordx4 v17, s[24:27], s53 offen lds
    s_add_u32 m0, s61, 4096
    s_nop 0
    buffer_load_dwordx4 v18, s[24:27], s53 offen lds
    s_add_u32 m0, s61, 5120
    s_nop 0
    buffer_load_dwordx4 v19, s[24:27], s53 offen lds
    s_add_u32 m0, s61, 6144
    s_nop 0
    buffer_load_dwordx4 v20, s[24:27], s53 offen lds
    s_add_u32 m0, s62, 0
    s_nop 0
    buffer_load_dwordx4 v10, s[20:23], s52 offen lds
    s_add_u32 m0, s62, 1024
    s_nop 0
    buffer_load_dwordx4 v11, s[20:23], s52 offen lds
    s_add_u32 m0, s62, 2048
    s_nop 0
    buffer_load_dwordx4 v12, s[20:23], s52 offen lds
    s_add_u32 m0, s62, 3072
    s_nop 0
    buffer_load_dwordx4 v13, s[20:23], s52 offen lds
    s_add_u32 s52, s52, 128
    s_add_u32 s53, s53, 458752
    s_cmp_eq_u32 s52, 2048
    s_cselect_b32 s52, 0, s52
    s_cselect_b32 s53, 0, s53
    s_add_u32 s56, s56, 45056
    s_cmp_eq_u32 s56, 135168
    s_cselect_b32 s56, 0, s56
    s_add_u32 s57, s57, 1
    s_cmp_lt_u32 s57, 2
    s_cbranch_scc1 P_loop
    s_cmp_eq_u32 s57, 2
    s_cbranch_scc0 P_pf
    s_waitcnt vmcnt(11)
    s_barrier
    s_branch P_loop
P_pf:
    s_load_dword s63, s[58:59], 0
    s_load_dword s63, s[58:59], 64
    s_load_dword s63, s[58:59], 128
    s_load_dword s63, s[58:59], 192
    s_load_dword s63, s[58:59], 256
    s_load_dword s63, s[58:59], 320
    s_load_dword s63, s[58:59], 384
    s_load_dword s63, s[58:59], 448
    s_add_u32 s58, s58, s60
    s_addc_u32 s59, s59, 0
    s_xor_b32 s60, s60, 1024
    s_cmp_lt_u32 s57, 16
    s_cbranch_scc1 P_loop
    s_lshr_b32 s49, s48, 1
    s_and_b32 s50, s48, 1
    s_mul_i32 s51, s42, 3670016
    s_add_u32 s28, s10, s51
    s_addc_u32 s29, s11, 0
    s_mov_b32 s30, 3670016
    s_mov_b32 s31, 0x20000
    s_mul_i32 s51, s40, 112
    s_mul_i32 s52, s42, 56
    s_add_u32 s51, s51, s52
    s_lshl_b32 s51, s51, 13
    s_add_u32 s32, s18, s51
    s_addc_u32 s33, s19, 0
    s_mov_b32 s34, 458752
    s_mov_b32 s35, 0x20000
    s_mov_b32 s36, s16
    s_mov_b32 s37, s17
    s_mov_b32 s38, 260
    s_mov_b32 s39, 0x20000
    s_lshl_b32 s51, s43, 8
    s_lshl_b32 s52, s50, 7
    s_add_u32 s51, s51, s52
    v_lshlrev_b32 v7, 1, v7
    v_xor_b32 v3, v6, v7
    v_lshl_add_u32 v3, v3, 4, v5
    v_add_u32 v21, s51, v3
    v_add_u32 v22, 16384, v21
    v_add_u32 v23, 32768, v21
    v_add_u32 v24, 49152, v21
    s_lshl_b32 s54, s50, 12
    v_lshl_add_u32 v25, v0, 4, s54
    s_mul_i32 s55, s43, 7
    s_add_u32 s44, s18, 0x1600000
    s_addc_u32 s45, s19, 0
    s_mov_b32 s46, 0x80000
    s_mov_b32 s47, 0x20000
    s_lshl_b32 s51, s40, 4
    v_mov_b32 v29, s51
    s_add_u32 s56, s51, s41
    s_lshl_b32 s56, s56, 11
    v_lshl_add_u32 v27, v6, 7, s56
    s_lshl_b32 s56, s42, 3
    s_add_u32 s51, s51, s56
    s_lshl_b32 s51, s51, 11
    s_lshl_b32 s56, s43, 7
    s_add_u32 s51, s51, s56
    v_lshl_add_u32 v26, v6, 4, v5
    v_add_u32 v26, s51, v26
    v_lshlrev_b32 v36, 4, v0
    v_add_u32 v36, 98304, v36
    s_mov_b32 s51, 0xff00
    s_bitset1_b32 s51, s43
    s_waitcnt vmcnt(11)
    s_barrier
    buffer_load_dwordx2 v[32:33], v29, s[36:39], 0 offen sc1
    s_xor_b32 s57, s49, 1
P_w0:
    s_lshl_b32 s61, s57, 13
    s_add_u32 s61, s61, s54
    s_add_u32 s53, s57, s55
    s_cmp_eq_u32 s57, 7
    s_cselect_b32 s53, 56, s53
    s_lshl_b32 s53, s53, 16
    s_add_u32 m0, s61, 98304
    s_nop 0
    buffer_load_dwordx4 v21, s[28:31], s53 offen lds
    s_add_u32 m0, s61, 99328
    s_nop 0
    buffer_load_dwordx4 v22, s[28:31], s53 offen lds
    s_add_u32 m0, s61, 100352
    s_nop 0
    buffer_load_dwordx4 v23, s[28:31], s53 offen lds
    s_add_u32 m0, s61, 101376
    s_nop 0
    buffer_load_dwordx4 v24, s[28:31], s53 offen lds
    s_add_u32 s57, s57, 2
    s_cmp_lt_u32 s57, 8
    s_cbranch_scc1 P_w0
    s_waitcnt vmcnt(17)
    s_barrier
    s_barrier
    s_mov_b32 s60, 0x100000
    s_waitcnt vmcnt(0) lgkmcnt(0)
P_nonce:
    v_readfirstlane_b32 s62, v32
    s_sub_u32 s60, s60, 1
    s_cbranch_scc1 P_n2
    s_cmp_eq_u32 s62, 0
    s_cbranch_scc0 P_n2
    buffer_load_dwordx2 v[32:33], v29, s[36:39], 0 offen sc1
    s_waitcnt vmcnt(0)
    s_branch P_nonce
P_n2:
    v_mov_b32 v34, v32
    v_mov_b32 v35, v33
    s_barrier
    s_barrier
    s_add_u32 s57, s49, 7
    s_and_b32 s61, s57, 7
    s_lshl_b32 s61, s61, 13
    s_add_u32 s61, s61, s54
    s_mul_i32 s62, s57, 37
    s_lshr_b32 s62, s62, 8
    s_cmp_gt_u32 s62, s43
    s_cselect_b32 s56, 0, -1
    s_add_u32 s56, s56, s62
    s_sub_u32 s52, s56, s62
    s_mul_i32 s52, s52, 7
    s_add_u32 s52, s52, s57
    s_lshl_b32 s53, s52, 16
    s_lshl_b32 s52, s52, 13
    s_add_u32 m0, s61, 98304
    s_nop 0
    buffer_load_dwordx4 v21, s[28:31], s53 offen lds
    s_add_u32 m0, s61, 99328
    s_nop 0
    buffer_load_dwordx4 v22, s[28:31], s53 offen lds
    s_add_u32 m0, s61, 100352
    s_nop 0
    buffer_load_dwordx4 v23, s[28:31], s53 offen lds
    s_add_u32 m0, s61, 101376
    s_nop 0
    buffer_load_dwordx4 v24, s[28:31], s53 offen lds
    s_barrier
    s_add_u32 s57, s49, 9
    s_and_b32 s61, s57, 7
    s_lshl_b32 s61, s61, 13
    s_add_u32 s61, s61, s54
    s_mul_i32 s62, s57, 37
    s_lshr_b32 s62, s62, 8
    s_cmp_gt_u32 s62, s43
    s_cselect_b32 s56, 0, -1
    s_add_u32 s56, s56, s62
    s_sub_u32 s52, s56, s62
    s_mul_i32 s52, s52, 7
    s_add_u32 s52, s52, s57
    s_lshl_b32 s53, s52, 16
    s_lshl_b32 s52, s52, 13
    s_add_u32 m0, s61, 98304
    s_nop 0
    buffer_load_dwordx4 v21, s[28:31], s53 offen lds
    s_add_u32 m0, s61, 99328
    s_nop 0
    buffer_load_dwordx4 v22, s[28:31], s53 offen lds
    s_add_u32 m0, s61, 100352
    s_nop 0
    buffer_load_dwordx4 v23, s[28:31], s53 offen lds
    s_add_u32 m0, s61, 101376
    s_nop 0
    buffer_load_dwordx4 v24, s[28:31], s53 offen lds
    buffer_load_dwordx2 v[38:39], v27, s[44:47], 0 offen sc1
    s_mov_b32 s60, 0x200000
    s_barrier
    s_cmp_eq_u32 s48, 0
    s_cbranch_scc0 P_noflag
    buffer_store_dwordx4 v[32:35], v26, s[44:47], 0 offen sc1
    s_waitcnt vmcnt(1)
    s_branch P_fl2
P_noflag:
    s_waitcnt vmcnt(0)
P_fl2:
    v_cmp_eq_u64 vcc, v[38:39], v[32:33]
    s_nop 1
    s_or_b32 s51, s51, vcc_lo
    s_add_u32 s57, s49, 11
    s_and_b32 s61, s57, 7
    s_lshl_b32 s61, s61, 13
    s_add_u32 s61, s61, s54
    s_mul_i32 s62, s57, 37
    s_lshr_b32 s62, s62, 8
    s_cmp_gt_u32 s62, s43
    s_cselect_b32 s56, 0, -1
    s_add_u32 s56, s56, s62
    s_sub_u32 s52, s56, s62
    s_mul_i32 s52, s52, 7
    s_add_u32 s52, s52, s57
    s_lshl_b32 s53, s52, 16
    s_lshl_b32 s52, s52, 13
    s_add_u32 m0, s61, 98304
    s_nop 0
    buffer_load_dwordx4 v21, s[28:31], s53 offen lds
    s_add_u32 m0, s61, 99328
    s_nop 0
    buffer_load_dwordx4 v22, s[28:31], s53 offen lds
    s_add_u32 m0, s61, 100352
    s_nop 0
    buffer_load_dwordx4 v23, s[28:31], s53 offen lds
    s_add_u32 m0, s61, 101376
    s_nop 0
    buffer_load_dwordx4 v24, s[28:31], s53 offen lds
P_q2:
    s_and_b32 s62, s51, 0xff
    s_cmp_eq_u32 s62, 0xff
    s_cbranch_scc1 P_k2
    s_sub_u32 s60, s60, 1
    s_cbranch_scc1 P_k2
    buffer_load_dwordx2 v[38:39], v27, s[44:47], 0 offen sc1
    s_waitcnt vmcnt(0)
    v_cmp_eq_u64 vcc, v[38:39], v[32:33]
    s_nop 1
    s_or_b32 s51, s51, vcc_lo
    s_branch P_q2
P_k2:
    s_add_u32 s57, s49, 7
    s_and_b32 s61, s57, 7
    s_lshl_b32 s61, s61, 13
    s_add_u32 s61, s61, s54
    s_mul_i32 s62, s57, 37
    s_lshr_b32 s62, s62, 8
    s_cmp_gt_u32 s62, s43
    s_cselect_b32 s56, 0, -1
    s_add_u32 s56, s56, s62
    s_sub_u32 s52, s56, s62
    s_mul_i32 s52, s52, 7
    s_add_u32 s52, s52, s57
    s_lshl_b32 s53, s52, 16
    s_lshl_b32 s52, s52, 13
    s_mov_b32 m0, s61
    s_nop 0
    buffer_load_dwordx4 v25, s[32:35], s52 offen offset:0 sc1 lds
    buffer_load_dwordx4 v25, s[32:35], s52 offen offset:1024 sc1 lds
    buffer_load_dwordx4 v25, s[32:35], s52 offen offset:2048 sc1 lds
    buffer_load_dwordx4 v25, s[32:35], s52 offen offset:3072 sc1 lds
    s_add_u32 s57, s49, 9
    s_and_b32 s61, s57, 7
    s_lshl_b32 s61, s61, 13
    s_add_u32 s61, s61, s54
    s_mul_i32 s62, s57, 37
    s_lshr_b32 s62, s62, 8
    s_cmp_gt_u32 s62, s43
    s_cselect_b32 s56, 0, -1
    s_add_u32 s56, s56, s62
    s_sub_u32 s52, s56, s62
    s_mul_i32 s52, s52, 7
    s_add_u32 s52, s52, s57
    s_lshl_b32 s53, s52, 16
    s_lshl_b32 s52, s52, 13
    s_mov_b32 m0, s61
    s_nop 0
    buffer_load_dwordx4 v25, s[32:35], s52 offen offset:0 sc1 lds
    buffer_load_dwordx4 v25, s[32:35], s52 offen offset:1024 sc1 lds
    buffer_load_dwordx4 v25, s[32:35], s52 offen offset:2048 sc1 lds
    buffer_load_dwordx4 v25, s[32:35], s52 offen offset:3072 sc1 lds
    s_add_u32 s57, s49, 11
    s_and_b32 s61, s57, 7
    s_lshl_b32 s61, s61, 13
    s_add_u32 s61, s61, s54
    s_mul_i32 s62, s57, 37
    s_lshr_b32 s62, s62, 8
    s_cmp_gt_u32 s62, s43
    s_cselect_b32 s56, 0, -1
    s_add_u32 s56, s56, s62
    s_sub_u32 s52, s56, s62
    s_mul_i32 s52, s52, 7
    s_add_u32 s52, s52, s57
    s_lshl_b32 s53, s52, 16
    s_lshl_b32 s52, s52, 13
    s_mov_b32 m0, s61
    s_nop 0
    buffer_load_dwordx4 v25, s[32:35], s52 offen offset:0 sc1 lds
    buffer_load_dwordx4 v25, s[32:35], s52 offen offset:1024 sc1 lds
    buffer_load_dwordx4 v25, s[32:35], s52 offen offset:2048 sc1 lds
    buffer_load_dwordx4 v25, s[32:35], s52 offen offset:3072 sc1 lds
    s_waitcnt vmcnt(8)
    s_barrier
    s_add_u32 s57, s49, 13
    s_and_b32 s61, s57, 7
    s_lshl_b32 s61, s61, 13
    s_add_u32 s61, s61, s54
    s_mul_i32 s62, s57, 37
    s_lshr_b32 s62, s62, 8
    s_cmp_gt_u32 s62, s43
    s_cselect_b32 s56, 0, -1
    s_add_u32 s56, s56, s62
    s_sub_u32 s52, s56, s62
    s_mul_i32 s52, s52, 7
    s_add_u32 s52, s52, s57
    s_lshl_b32 s53, s52, 16
    s_lshl_b32 s52, s52, 13
    s_mov_b32 m0, s61
    s_nop 0
    buffer_load_dwordx4 v25, s[32:35], s52 offen offset:0 sc1 lds
    buffer_load_dwordx4 v25, s[32:35], s52 offen offset:1024 sc1 lds
    buffer_load_dwordx4 v25, s[32:35], s52 offen offset:2048 sc1 lds
    buffer_load_dwordx4 v25, s[32:35], s52 offen offset:3072 sc1 lds
    s_add_u32 m0, s61, 98304
    s_nop 0
    buffer_load_dwordx4 v21, s[28:31], s53 offen lds
    s_add_u32 m0, s61, 99328
    s_nop 0
    buffer_load_dwordx4 v22, s[28:31], s53 offen lds
    s_add_u32 m0, s61, 100352
    s_nop 0
    buffer_load_dwordx4 v23, s[28:31], s53 offen lds
    s_add_u32 m0, s61, 101376
    s_nop 0
    buffer_load_dwordx4 v24, s[28:31], s53 offen lds
    s_waitcnt vmcnt(12)
    s_barrier
P_g2:
    s_add_u32 s57, s49, 15
    s_and_b32 s61, s57, 7
    s_lshl_b32 s61, s61, 13
    s_add_u32 s61, s61, s54
    s_mul_i32 s62, s57, 37
    s_lshr_b32 s62, s62, 8
    s_cmp_gt_u32 s62, s43
    s_cselect_b32 s56, 0, -1
    s_add_u32 s56, s56, s62
    s_sub_u32 s52, s56, s62
    s_mul_i32 s52, s52, 7
    s_add_u32 s52, s52, s57
    s_lshl_b32 s53, s52, 16
    s_lshl_b32 s52, s52, 13
    s_mov_b32 m0, s61
    s_nop 0
    buffer_load_dwordx4 v25, s[32:35], s52 offen offset:0 sc1 lds
    buffer_load_dwordx4 v25, s[32:35], s52 offen offset:1024 sc1 lds
    buffer_load_dwordx4 v25, s[32:35], s52 offen offset:2048 sc1 lds
    buffer_load_dwordx4 v25, s[32:35], s52 offen offset:3072 sc1 lds
    s_add_u32 m0, s61, 98304
    s_nop 0
    buffer_load_dwordx4 v21, s[28:31], s53 offen lds
    s_add_u32 m0, s61, 99328
    s_nop 0
    buffer_load_dwordx4 v22, s[28:31], s53 offen lds
    s_add_u32 m0, s61, 100352
    s_nop 0
    buffer_load_dwordx4 v23, s[28:31], s53 offen lds
    s_add_u32 m0, s61, 101376
    s_nop 0
    buffer_load_dwordx4 v24, s[28:31], s53 offen lds
    s_add_u32 s49, s49, 2
    s_cmp_lt_u32 s49, 42
    s_waitcnt vmcnt(16)
    s_barrier
    s_cbranch_scc1 P_g2
    s_waitcnt vmcnt(8)
    s_barrier
    s_waitcnt vmcnt(0)
    s_barrier
    s_waitcnt vmcnt(0) lgkmcnt(0)
    s_endpgm
L_cons:
    s_and_b32 s48, s3, 1
    s_lshr_b32 s49, s3, 1
    v_and_b32 v1, 15, v0
    v_lshrrev_b32 v2, 4, v0
    s_lshl_b32 s50, s49, 8
    s_add_u32 s50, s50, s47
    v_lshlrev_b32 v3, 3, v2
    v_add_u32 v14, s50, v3
    s_lshl_b32 s50, s49, 5
    s_add_u32 s50, s50, s47
    s_add_u32 s50, s50, 192
    v_add_u32 v15, s50, v3
    s_lshl_b32 s50, s43, 8
    s_lshl_b32 s51, s49, 7
    s_add_u32 s58, s50, s51
    v_add_u32 v16, s58, v3
    s_waitcnt lgkmcnt(0)
    s_mov_b32 s20, s8
    s_mov_b32 s21, s9
    s_mov_b32 s22, 7168
    s_mov_b32 s23, 0x20000
    s_mov_b32 s28, s12
    s_mov_b32 s29, s13
    s_mov_b32 s30, 2048
    s_mov_b32 s31, 0x20000
    buffer_load_dwordx2 v[84:85], v14, s[20:23], 0 offen offset:0
    buffer_load_dwordx2 v[86:87], v14, s[20:23], 0 offen offset:32
    buffer_load_dwordx2 v[88:89], v14, s[20:23], 0 offen offset:64
    buffer_load_dwordx2 v[90:91], v14, s[20:23], 0 offen offset:96
    buffer_load_dwordx2 v[92:93], v14, s[20:23], 0 offen offset:128
    buffer_load_dwordx2 v[94:95], v14, s[20:23], 0 offen offset:160
    buffer_load_dwordx2 v[96:97], v15, s[20:23], 0 offen
    buffer_load_dwordx2 v[98:99], v16, s[28:31], 0 offen offset:0
    buffer_load_dwordx2 v[100:101], v16, s[28:31], 0 offen offset:32
    buffer_load_dwordx2 v[102:103], v16, s[28:31], 0 offen offset:64
    buffer_load_dwordx2 v[104:105], v16, s[28:31], 0 offen offset:96
    s_mov_b32 s24, s18
    s_mov_b32 s25, s19
    s_mov_b32 s26, 0x1600000
    s_mov_b32 s27, 0x20000
    s_mov_b32 s32, s14
    s_mov_b32 s33, s15
    s_mov_b32 s34, 0x400000
    s_mov_b32 s35, 0x20000
    s_mov_b32 s36, s16
    s_mov_b32 s37, s17
    s_mov_b32 s38, 260
    s_mov_b32 s39, 0x20000
    s_lshl_b32 s50, s40, 4
    v_mov_b32 v243, s50
    s_or_b32 s50, s41, s3
    s_cmp_eq_u32 s50, 0
    s_cbranch_scc0 C_nn
    s_memrealtime s[50:51]
    s_waitcnt lgkmcnt(0)
    s_or_b32 s50, s50, 1
    s_mul_i32 s50, s50, 0x9e3779b1
    v_mov_b32 v244, s50
    v_mov_b32 v245, s51
    s_mov_b64 exec, 1
    buffer_store_dwordx2 v[244:245], v243, s[36:39], 0 offen sc1
    s_mov_b64 exec, -1
C_nn:
    s_add_u32 s44, s18, 0x1600000
    s_addc_u32 s45, s19, 0
    s_mov_b32 s46, 0x80000
    s_mov_b32 s47, 0x20000
    s_lshl_b32 s50, s48, 13
    v_lshrrev_b32 v3, 1, v1
    v_xor_b32 v3, v3, v2
    v_lshlrev_b32 v3, 4, v3
    v_lshl_add_u32 v3, v1, 7, v3
    v_add_u32 v4, s50, v3
    v_xor_b32 v5, 64, v4
    v_lshrrev_b32 v3, 2, v1
    v_lshl_add_u32 v3, v2, 3, v3
    v_mul_u32_u24 v3, 448, v3
    v_and_b32 v16, 3, v1
    v_lshl_add_u32 v3, v16, 3, v3
    v_add_u32 v3, 16384, v3
    v_and_b32 v16, 1, v2
    v_lshlrev_b32 v17, 5, v16
    s_lshl_b32 s50, s49, 8
    v_add_u32 v18, s50, v3
    v_add_u32 v6, v18, v17
    v_sub_u32 v7, v18, v17
    s_add_u32 s50, s49, 6
    v_xor_b32 v16, s50, v16
    v_lshl_add_u32 v8, v16, 5, v3
    s_mov_b32 s52, 45056
    v_add_u32 v9, s52, v4
    v_add_u32 v10, s52, v5
    v_add_u32 v11, s52, v6
    v_add_u32 v12, s52, v7
    v_add_u32 v13, s52, v8
    s_mul_i32 s50, s40, 112
    s_mul_i32 s51, s41, 7
    s_add_u32 s50, s50, s51
    s_lshl_b32 s50, s50, 13
    s_lshl_b32 s51, s48, 12
    v_lshl_add_u32 v3, v0, 4, s51
    s_lshl_b32 s51, s49, 15
    v_add_u32 v19, s51, v3
    v_add_u32 v14, s50, v19
    s_lshl_b32 s51, s49, 3
    s_add_u32 s51, s51, 24576
    v_add_u32 v20, s51, v3
    v_add_u32 v15, s50, v20
    s_lshl_b32 s51, s3, 11
    s_add_u32 s51, s51, 24576
    v_lshl_add_u32 v246, v0, 4, s51
    v_add_u32 v15, s50, v246
    s_lshl_b32 s51, s42, 11
    v_add_u32 v232, s51, v3
    v_xor_b32 v233, 0x800, v232
    v_lshrrev_b32 v3, 2, v1
    v_lshl_add_u32 v3, v2, 2, v3
    v_lshrrev_b32 v16, 1, v3
    v_and_b32 v16, 3, v16
    v_lshlrev_b32 v16, 5, v16
    v_lshl_add_u32 v3, v3, 7, v16
    v_and_b32 v16, 3, v1
    v_lshl_add_u32 v3, v16, 3, v3
    s_lshl_b32 s51, s49, 12
    s_add_u32 s51, s51, 98304
    v_add_u32 v234, s51, v3
    v_xor_b32 v235, 32, v234
    v_xor_b32 v236, 64, v234
    v_xor_b32 v237, 96, v234
    s_lshl_b32 s50, s40, 4
    s_add_u32 s50, s50, s41
    s_lshl_b32 s51, s50, 4
    s_add_u32 s51, s51, s3
    s_add_u32 s51, s51, 8
    s_lshl_b32 s51, s51, 7
    v_lshl_add_u32 v241, v0, 4, s51
    v_xor_b32 v242, 0x4000, v241
    s_lshl_b32 s50, s50, 15
    s_lshl_b32 s51, s3, 13
    s_add_u32 s50, s50, s51
    s_add_u32 s50, s50, 0xe00000
    v_lshl_add_u32 v238, v0, 4, s50
    v_xor_b32 v239, 0x40000, v238
    s_lshl_b32 s50, s40, 18
    s_lshl_b32 s51, s48, 17
    s_add_u32 s50, s50, s51
    s_lshl_b32 s51, s42, 16
    s_add_u32 s50, s50, s51
    s_add_u32 s50, s50, s58
    v_and_b32 v3, 1, v2
    v_lshlrev_b32 v3, 5, v3
    v_lshrrev_b32 v16, 1, v2
    v_lshl_add_u32 v3, v16, 4, v3
    v_lshl_add_u32 v3, v1, 11, v3
    v_add_u32 v240, s50, v3
    s_mov_b32 s57, 0
    s_movk_i32 s54, 0x2000
    s_movk_i32 s55, 0x4000
    s_movk_i32 s59, 0x1000
    s_mov_b32 s60, 0x8000
    s_waitcnt vmcnt(0)
    v_lshlrev_b32 v112, 16, v84
    v_and_b32 v113, 0xffff0000, v84
    v_lshlrev_b32 v114, 16, v85
    v_and_b32 v115, 0xffff0000, v85
    v_pk_mov_b32 v[116:117], v[112:113], v[112:113] op_sel:[0,1]
    v_pk_mov_b32 v[118:119], v[114:115], v[114:115] op_sel:[0,1]
    v_pk_mov_b32 v[120:121], v[112:113], v[112:113] op_sel:[0,1]
    v_pk_mov_b32 v[122:123], v[114:115], v[114:115] op_sel:[0,1]
    v_pk_mov_b32 v[124:125], v[112:113], v[112:113] op_sel:[0,1]
    v_pk_mov_b32 v[126:127], v[114:115], v[114:115] op_sel:[0,1]
    v_lshlrev_b32 v128, 16, v86
    v_and_b32 v129, 0xffff0000, v86
    v_lshlrev_b32 v130, 16, v87
    v_and_b32 v131, 0xffff0000, v87
    v_pk_mov_b32 v[132:133], v[128:129], v[128:129] op_sel:[0,1]
    v_pk_mov_b32 v[134:135], v[130:131], v[130:131] op_sel:[0,1]
    v_pk_mov_b32 v[136:137], v[128:129], v[128:129] op_sel:[0,1]
    v_pk_mov_b32 v[138:139], v[130:131], v[130:131] op_sel:[0,1]
    v_pk_mov_b32 v[140:141], v[128:129], v[128:129] op_sel:[0,1]
    v_pk_mov_b32 v[142:143], v[130:131], v[130:131] op_sel:[0,1]
    v_lshlrev_b32 v144, 16, v88
    v_and_b32 v145, 0xffff0000, v88
    v_lshlrev_b32 v146, 16, v89
    v_and_b32 v147, 0xffff0000, v89
    v_pk_mov_b32 v[148:149], v[144:145], v[144:145] op_sel:[0,1]
    v_pk_mov_b32 v[150:151], v[146:147], v[146:147] op_sel:[0,1]
    v_pk_mov_b32 v[152:153], v[144:145], v[144:145] op_sel:[0,1]
    v_pk_mov_b32 v[154:155], v[146:147], v[146:147] op_sel:[0,1]
    v_pk_mov_b32 v[156:157], v[144:145], v[144:145] op_sel:[0,1]
    v_pk_mov_b32 v[158:159], v[146:147], v[146:147] op_sel:[0,1]
    v_lshlrev_b32 v160, 16, v90
    v_and_b32 v161, 0xffff0000, v90
    v_lshlrev_b32 v162, 16, v91
    v_and_b32 v163, 0xffff0000, v91
    v_pk_mov_b32 v[164:165], v[160:161], v[160:161] op_sel:[0,1]
    v_pk_mov_b32 v[166:167], v[162:163], v[162:163] op_sel:[0,1]
    v_pk_mov_b32 v[168:169], v[160:161], v[160:161] op_sel:[0,1]
    v_pk_mov_b32 v[170:171], v[162:163], v[162:163] op_sel:[0,1]
    v_pk_mov_b32 v[172:173], v[160:161], v[160:161] op_sel:[0,1]
    v_pk_mov_b32 v[174:175], v[162:163], v[162:163] op_sel:[0,1]
    v_lshlrev_b32 v176, 16, v92
    v_and_b32 v177, 0xffff0000, v92
    v_lshlrev_b32 v178, 16, v93
    v_and_b32 v179, 0xffff0000, v93
    v_pk_mov_b32 v[180:181], v[176:177], v[176:177] op_sel:[0,1]
    v_pk_mov_b32 v[182:183], v[178:179], v[178:179] op_sel:[0,1]
    v_pk_mov_b32 v[184:185], v[176:177], v[176:177] op_sel:[0,1]
    v_pk_mov_b32 v[186:187], v[178:179], v[178:179] op_sel:[0,1]
    v_pk_mov_b32 v[188:189], v[176:177], v[176:177] op_sel:[0,1]
    v_pk_mov_b32 v[190:191], v[178:179], v[178:179] op_sel:[0,1]
    v_lshlrev_b32 v192, 16, v94
    v_and_b32 v193, 0xffff0000, v94
    v_lshlrev_b32 v194, 16, v95
    v_and_b32 v195, 0xffff0000, v95
    v_pk_mov_b32 v[196:197], v[192:193], v[192:193] op_sel:[0,1]
    v_pk_mov_b32 v[198:199], v[194:195], v[194:195] op_sel:[0,1]
    v_pk_mov_b32 v[200:201], v[192:193], v[192:193] op_sel:[0,1]
    v_pk_mov_b32 v[202:203], v[194:195], v[194:195] op_sel:[0,1]
    v_pk_mov_b32 v[204:205], v[192:193], v[192:193] op_sel:[0,1]
    v_pk_mov_b32 v[206:207], v[194:195], v[194:195] op_sel:[0,1]
    v_lshlrev_b32 v208, 16, v96
    v_and_b32 v209, 0xffff0000, v96
    v_lshlrev_b32 v210, 16, v97
    v_and_b32 v211, 0xffff0000, v97
    v_pk_mov_b32 v[212:213], v[208:209], v[208:209] op_sel:[0,1]
    v_pk_mov_b32 v[214:215], v[210:211], v[210:211] op_sel:[0,1]
    v_pk_mov_b32 v[216:217], v[208:209], v[208:209] op_sel:[0,1]
    v_pk_mov_b32 v[218:219], v[210:211], v[210:211] op_sel:[0,1]
    v_pk_mov_b32 v[220:221], v[208:209], v[208:209] op_sel:[0,1]
    v_pk_mov_b32 v[222:223], v[210:211], v[210:211] op_sel:[0,1]
    v_lshlrev_b32 v224, 16, v98
    v_and_b32 v225, 0xffff0000, v98
    v_lshlrev_b32 v226, 16, v99
    v_and_b32 v227, 0xffff0000, v99
    v_lshlrev_b32 v228, 16, v100
    v_and_b32 v229, 0xffff0000, v100
    v_lshlrev_b32 v230, 16, v101
    v_and_b32 v231, 0xffff0000, v101
    v_lshlrev_b32 v248, 16, v102
    v_and_b32 v249, 0xffff0000, v102
    v_lshlrev_b32 v250, 16, v103
    v_and_b32 v251, 0xffff0000, v103
    v_lshlrev_b32 v252, 16, v104
    v_and_b32 v253, 0xffff0000, v104
    v_lshlrev_b32 v254, 16, v105
    v_and_b32 v255, 0xffff0000, v105
    s_barrier
    ds_read_b64_tr_b16 v[56:57], v11 offset:0
    ds_read_b64_tr_b16 v[58:59], v11 offset:1792
    ds_read_b128 v[24:27], v9 offset:0
    ds_read_b128 v[28:31], v9 offset:2048
    ds_read_b128 v[32:35], v9 offset:4096
    ds_read_b128 v[36:39], v9 offset:6144
    ds_read_b64_tr_b16 v[60:61], v12 offset:32
    ds_read_b64_tr_b16 v[62:63], v12 offset:1824
    ds_read_b64_tr_b16 v[64:65], v11 offset:64
    ds_read_b64_tr_b16 v[66:67], v11 offset:1856
    ds_read_b64_tr_b16 v[68:69], v12 offset:96
    ds_read_b64_tr_b16 v[70:71], v12 offset:1888
    ds_read_b64_tr_b16 v[72:73], v11 offset:128
    ds_read_b64_tr_b16 v[74:75], v11 offset:1920
    ds_read_b64_tr_b16 v[76:77], v12 offset:160
    ds_read_b64_tr_b16 v[78:79], v12 offset:1952
    ds_read_b64_tr_b16 v[80:81], v13 offset:0
    ds_read_b64_tr_b16 v[82:83], v13 offset:1792
    s_waitcnt lgkmcnt(0)
.p2align 3
C_g1:
    v_mfma_f32_16x16x32_bf16 v[112:115], v[56:59], v[24:27], v[112:115]
    ds_read_b64_tr_b16 v[84:85], v11 offset:14336
    v_mfma_f32_16x16x32_bf16 v[116:119], v[56:59], v[28:31], v[116:119]
    ds_read_b64_tr_b16 v[86:87], v11 offset:16128
    v_mfma_f32_16x16x32_bf16 v[120:123], v[56:59], v[32:35], v[120:123]
    ds_read_b128 v[40:43], v10 offset:0
    v_mfma_f32_16x16x32_bf16 v[124:127], v[56:59], v[36:39], v[124:127]
    ds_read_b128 v[44:47], v10 offset:2048
    v_mfma_f32_16x16x32_bf16 v[140:143], v[60:63], v[36:39], v[140:143]
    ds_read_b128 v[48:51], v10 offset:4096
    v_mfma_f32_16x16x32_bf16 v[136:139], v[60:63], v[32:35], v[136:139]
    ds_read_b128 v[52:55], v10 offset:6144
    v_mfma_f32_16x16x32_bf16 v[132:135], v[60:63], v[28:31], v[132:135]
    ds_read_b64_tr_b16 v[88:89], v12 offset:14368
    v_mfma_f32_16x16x32_bf16 v[128:131], v[60:63], v[24:27], v[128:131]
    ds_read_b64_tr_b16 v[90:91], v12 offset:16160
    v_mfma_f32_16x16x32_bf16 v[144:147], v[64:67], v[24:27], v[144:147]
    ds_read_b64_tr_b16 v[92:93], v11 offset:14400
    v_mfma_f32_16x16x32_bf16 v[148:151], v[64:67], v[28:31], v[148:151]
    ds_read_b64_tr_b16 v[94:95], v11 offset:16192
    v_mfma_f32_16x16x32_bf16 v[152:155], v[64:67], v[32:35], v[152:155]
    ds_read_b64_tr_b16 v[96:97], v12 offset:14432
    v_mfma_f32_16x16x32_bf16 v[156:159], v[64:67], v[36:39], v[156:159]
    ds_read_b64_tr_b16 v[98:99], v12 offset:16224
    v_mfma_f32_16x16x32_bf16 v[172:175], v[68:71], v[36:39], v[172:175]
    ds_read_b64_tr_b16 v[100:101], v11 offset:14464
    v_mfma_f32_16x16x32_bf16 v[168:171], v[68:71], v[32:35], v[168:171]
    ds_read_b64_tr_b16 v[102:103], v11 offset:16256
    v_mfma_f32_16x16x32_bf16 v[164:167], v[68:71], v[28:31], v[164:167]
    ds_read_b64_tr_b16 v[104:105], v12 offset:14496
    v_mfma_f32_16x16x32_bf16 v[160:163], v[68:71], v[24:27], v[160:163]
    ds_read_b64_tr_b16 v[106:107], v12 offset:16288
    v_mfma_f32_16x16x32_bf16 v[176:179], v[72:75], v[24:27], v[176:179]
    ds_read_b64_tr_b16 v[108:109], v13 offset:14336
    v_mfma_f32_16x16x32_bf16 v[180:183], v[72:75], v[28:31], v[180:183]
    ds_read_b64_tr_b16 v[110:111], v13 offset:16128
    v_mfma_f32_16x16x32_bf16 v[184:187], v[72:75], v[32:35], v[184:187]
    s_add_u32 s52, s52, 45056
    s_cmp_eq_u32 s52, 135168
    s_cselect_b32 s52, 0, s52
    v_mfma_f32_16x16x32_bf16 v[188:191], v[72:75], v[36:39], v[188:191]
    v_add_u32 v9, s52, v4
    v_mfma_f32_16x16x32_bf16 v[204:207], v[76:79], v[36:39], v[204:207]
    v_add_u32 v10, s52, v5
    v_mfma_f32_16x16x32_bf16 v[200:203], v[76:79], v[32:35], v[200:203]
    v_add_u32 v11, s52, v6
    v_mfma_f32_16x16x32_bf16 v[196:199], v[76:79], v[28:31], v[196:199]
    v_add_u32 v12, s52, v7
    v_mfma_f32_16x16x32_bf16 v[192:195], v[76:79], v[24:27], v[192:195]
    v_add_u32 v13, s52, v8
    v_mfma_f32_16x16x32_bf16 v[208:211], v[80:83], v[24:27], v[208:211]
    v_mfma_f32_16x16x32_bf16 v[212:215], v[80:83], v[28:31], v[212:215]
    v_mfma_f32_16x16x32_bf16 v[216:219], v[80:83], v[32:35], v[216:219]
    v_mfma_f32_16x16x32_bf16 v[220:223], v[80:83], v[36:39], v[220:223]
    s_waitcnt lgkmcnt(0)
    s_barrier
    v_mfma_f32_16x16x32_bf16 v[112:115], v[84:87], v[40:43], v[112:115]
    ds_read_b64_tr_b16 v[56:57], v11 offset:0
    v_mfma_f32_16x16x32_bf16 v[116:119], v[84:87], v[44:47], v[116:119]
    ds_read_b64_tr_b16 v[58:59], v11 offset:1792
    v_mfma_f32_16x16x32_bf16 v[120:123], v[84:87], v[48:51], v[120:123]
    ds_read_b128 v[24:27], v9 offset:0
    v_mfma_f32_16x16x32_bf16 v[124:127], v[84:87], v[52:55], v[124:127]
    ds_read_b128 v[28:31], v9 offset:2048
    v_mfma_f32_16x16x32_bf16 v[140:143], v[88:91], v[52:55], v[140:143]
    ds_read_b128 v[32:35], v9 offset:4096
    v_mfma_f32_16x16x32_bf16 v[136:139], v[88:91], v[48:51], v[136:139]
    ds_read_b128 v[36:39], v9 offset:6144
    v_mfma_f32_16x16x32_bf16 v[132:135], v[88:91], v[44:47], v[132:135]
    ds_read_b64_tr_b16 v[60:61], v12 offset:32
    v_mfma_f32_16x16x32_bf16 v[128:131], v[88:91], v[40:43], v[128:131]
    ds_read_b64_tr_b16 v[62:63], v12 offset:1824
    v_mfma_f32_16x16x32_bf16 v[144:147], v[92:95], v[40:43], v[144:147]
    ds_read_b64_tr_b16 v[64:65], v11 offset:64
    v_mfma_f32_16x16x32_bf16 v[148:151], v[92:95], v[44:47], v[148:151]
    ds_read_b64_tr_b16 v[66:67], v11 offset:1856
    v_mfma_f32_16x16x32_bf16 v[152:155], v[92:95], v[48:51], v[152:155]
    ds_read_b64_tr_b16 v[68:69], v12 offset:96
    v_mfma_f32_16x16x32_bf16 v[156:159], v[92:95], v[52:55], v[156:159]
    ds_read_b64_tr_b16 v[70:71], v12 offset:1888
    v_mfma_f32_16x16x32_bf16 v[172:175], v[96:99], v[52:55], v[172:175]
    ds_read_b64_tr_b16 v[72:73], v11 offset:128
    v_mfma_f32_16x16x32_bf16 v[168:171], v[96:99], v[48:51], v[168:171]
    ds_read_b64_tr_b16 v[74:75], v11 offset:1920
    v_mfma_f32_16x16x32_bf16 v[164:167], v[96:99], v[44:47], v[164:167]
    ds_read_b64_tr_b16 v[76:77], v12 offset:160
    v_mfma_f32_16x16x32_bf16 v[160:163], v[96:99], v[40:43], v[160:163]
    ds_read_b64_tr_b16 v[78:79], v12 offset:1952
    v_mfma_f32_16x16x32_bf16 v[176:179], v[100:103], v[40:43], v[176:179]
    ds_read_b64_tr_b16 v[80:81], v13 offset:0
    v_mfma_f32_16x16x32_bf16 v[180:183], v[100:103], v[44:47], v[180:183]
    ds_read_b64_tr_b16 v[82:83], v13 offset:1792
    v_mfma_f32_16x16x32_bf16 v[184:187], v[100:103], v[48:51], v[184:187]
    s_add_u32 s57, s57, 1
    s_cmp_lt_u32 s57, 15
    v_mfma_f32_16x16x32_bf16 v[188:191], v[100:103], v[52:55], v[188:191]
    v_mfma_f32_16x16x32_bf16 v[204:207], v[104:107], v[52:55], v[204:207]
    v_mfma_f32_16x16x32_bf16 v[200:203], v[104:107], v[48:51], v[200:203]
    v_mfma_f32_16x16x32_bf16 v[196:199], v[104:107], v[44:47], v[196:199]
    v_mfma_f32_16x16x32_bf16 v[192:195], v[104:107], v[40:43], v[192:195]
    v_mfma_f32_16x16x32_bf16 v[208:211], v[108:111], v[40:43], v[208:211]
    v_mfma_f32_16x16x32_bf16 v[212:215], v[108:111], v[44:47], v[212:215]
    v_mfma_f32_16x16x32_bf16 v[216:219], v[108:111], v[48:51], v[216:219]
    v_mfma_f32_16x16x32_bf16 v[220:223], v[108:111], v[52:55], v[220:223]
    s_waitcnt lgkmcnt(0)
    s_cbranch_scc1 C_g1
    v_mfma_f32_16x16x32_bf16 v[112:115], v[56:59], v[24:27], v[112:115]
    ds_read_b64_tr_b16 v[84:85], v11 offset:14336
    v_mfma_f32_16x16x32_bf16 v[116:119], v[56:59], v[28:31], v[116:119]
    ds_read_b64_tr_b16 v[86:87], v11 offset:16128
    v_mfma_f32_16x16x32_bf16 v[120:123], v[56:59], v[32:35], v[120:123]
    ds_read_b128 v[40:43], v10 offset:0
    v_mfma_f32_16x16x32_bf16 v[124:127], v[56:59], v[36:39], v[124:127]
    ds_read_b128 v[44:47], v10 offset:2048
    v_mfma_f32_16x16x32_bf16 v[140:143], v[60:63], v[36:39], v[140:143]
    ds_read_b128 v[48:51], v10 offset:4096
    v_mfma_f32_16x16x32_bf16 v[136:139], v[60:63], v[32:35], v[136:139]
    ds_read_b128 v[52:55], v10 offset:6144
    v_mfma_f32_16x16x32_bf16 v[132:135], v[60:63], v[28:31], v[132:135]
    ds_read_b64_tr_b16 v[88:89], v12 offset:14368
    v_mfma_f32_16x16x32_bf16 v[128:131], v[60:63], v[24:27], v[128:131]
    ds_read_b64_tr_b16 v[90:91], v12 offset:16160
    v_mfma_f32_16x16x32_bf16 v[144:147], v[64:67], v[24:27], v[144:147]
    ds_read_b64_tr_b16 v[92:93], v11 offset:14400
    v_mfma_f32_16x16x32_bf16 v[148:151], v[64:67], v[28:31], v[148:151]
    ds_read_b64_tr_b16 v[94:95], v11 offset:16192
    v_mfma_f32_16x16x32_bf16 v[152:155], v[64:67], v[32:35], v[152:155]
    ds_read_b64_tr_b16 v[96:97], v12 offset:14432
    v_mfma_f32_16x16x32_bf16 v[156:159], v[64:67], v[36:39], v[156:159]
    ds_read_b64_tr_b16 v[98:99], v12 offset:16224
    v_mfma_f32_16x16x32_bf16 v[172:175], v[68:71], v[36:39], v[172:175]
    ds_read_b64_tr_b16 v[100:101], v11 offset:14464
    v_mfma_f32_16x16x32_bf16 v[168:171], v[68:71], v[32:35], v[168:171]
    ds_read_b64_tr_b16 v[102:103], v11 offset:16256
    v_mfma_f32_16x16x32_bf16 v[164:167], v[68:71], v[28:31], v[164:167]
    ds_read_b64_tr_b16 v[104:105], v12 offset:14496
    v_mfma_f32_16x16x32_bf16 v[160:163], v[68:71], v[24:27], v[160:163]
    ds_read_b64_tr_b16 v[106:107], v12 offset:16288
    v_mfma_f32_16x16x32_bf16 v[176:179], v[72:75], v[24:27], v[176:179]
    ds_read_b64_tr_b16 v[108:109], v13 offset:14336
    v_mfma_f32_16x16x32_bf16 v[180:183], v[72:75], v[28:31], v[180:183]
    ds_read_b64_tr_b16 v[110:111], v13 offset:16128
    v_mfma_f32_16x16x32_bf16 v[184:187], v[72:75], v[32:35], v[184:187]
    v_mfma_f32_16x16x32_bf16 v[188:191], v[72:75], v[36:39], v[188:191]
    s_waitcnt lgkmcnt(0)
    s_barrier
    v_mfma_f32_16x16x32_bf16 v[112:115], v[84:87], v[40:43], v[112:115]
    v_mfma_f32_16x16x32_bf16 v[116:119], v[84:87], v[44:47], v[116:119]
    v_mfma_f32_16x16x32_bf16 v[120:123], v[84:87], v[48:51], v[120:123]
    v_mfma_f32_16x16x32_bf16 v[124:127], v[84:87], v[52:55], v[124:127]
    v_mfma_f32_16x16x32_bf16 v[140:143], v[88:91], v[52:55], v[140:143]
    v_mfma_f32_16x16x32_bf16 v[136:139], v[88:91], v[48:51], v[136:139]
    v_mfma_f32_16x16x32_bf16 v[132:135], v[88:91], v[44:47], v[132:135]
    v_mfma_f32_16x16x32_bf16 v[128:131], v[88:91], v[40:43], v[128:131]
    v_mfma_f32_16x16x32_bf16 v[144:147], v[92:95], v[40:43], v[144:147]
    v_mul_f32_e64 v124, v124, |v124|
    v_mul_f32_e64 v125, v125, |v125|
    v_cvt_pk_bf16_f32 v124, v124, v125
    v_mfma_f32_16x16x32_bf16 v[148:151], v[92:95], v[44:47], v[148:151]
    v_pk_max_i16 v124, v124, 0
    v_mul_f32_e64 v126, v126, |v126|
    v_mul_f32_e64 v127, v127, |v127|
    v_mfma_f32_16x16x32_bf16 v[152:155], v[92:95], v[48:51], v[152:155]
    v_cvt_pk_bf16_f32 v125, v126, v127
    v_pk_max_i16 v125, v125, 0
    v_mul_f32_e64 v140, v140, |v140|
    v_mfma_f32_16x16x32_bf16 v[156:159], v[92:95], v[52:55], v[156:159]
    v_mul_f32_e64 v141, v141, |v141|
    v_cvt_pk_bf16_f32 v126, v140, v141
    v_pk_max_i16 v126, v126, 0
    v_mfma_f32_16x16x32_bf16 v[172:175], v[96:99], v[52:55], v[172:175]
    v_mul_f32_e64 v142, v142, |v142|
    v_mul_f32_e64 v143, v143, |v143|
    v_cvt_pk_bf16_f32 v127, v142, v143
    v_mfma_f32_16x16x32_bf16 v[168:171], v[96:99], v[48:51], v[168:171]
    v_pk_max_i16 v127, v127, 0
    buffer_store_dwordx4 v[124:127], v14, s[24:27], 0 offen offset:3072 sc1
    ds_write_b128 v19, v[124:127] offset:3072
    v_mfma_f32_16x16x32_bf16 v[164:167], v[96:99], v[44:47], v[164:167]
    v_mul_f32_e64 v120, v120, |v120|
    v_mul_f32_e64 v121, v121, |v121|
    v_cvt_pk_bf16_f32 v120, v120, v121
    v_mfma_f32_16x16x32_bf16 v[160:163], v[96:99], v[40:43], v[160:163]
    v_pk_max_i16 v120, v120, 0
    v_mul_f32_e64 v122, v122, |v122|
    v_mul_f32_e64 v123, v123, |v123|
    v_mfma_f32_16x16x32_bf16 v[192:195], v[76:79], v[24:27], v[192:195]
    v_cvt_pk_bf16_f32 v121, v122, v123
    v_pk_max_i16 v121, v121, 0
    v_mul_f32_e64 v136, v136, |v136|
    v_mfma_f32_16x16x32_bf16 v[196:199], v[76:79], v[28:31], v[196:199]
    v_mul_f32_e64 v137, v137, |v137|
    v_cvt_pk_bf16_f32 v122, v136, v137
    v_pk_max_i16 v122, v122, 0
    v_mfma_f32_16x16x32_bf16 v[200:203], v[76:79], v[32:35], v[200:203]
    v_mul_f32_e64 v138, v138, |v138|
    v_mul_f32_e64 v139, v139, |v139|
    v_cvt_pk_bf16_f32 v123, v138, v139
    v_mfma_f32_16x16x32_bf16 v[204:207], v[76:79], v[36:39], v[204:207]
    v_pk_max_i16 v123, v123, 0
    buffer_store_dwordx4 v[120:123], v14, s[24:27], 0 offen offset:2048 sc1
    ds_write_b128 v19, v[120:123] offset:2048
    v_mfma_f32_16x16x32_bf16 v[188:191], v[100:103], v[52:55], v[188:191]
    v_mul_f32_e64 v116, v116, |v116|
    v_mul_f32_e64 v117, v117, |v117|
    v_cvt_pk_bf16_f32 v116, v116, v117
    v_mfma_f32_16x16x32_bf16 v[184:187], v[100:103], v[48:51], v[184:187]
    v_pk_max_i16 v116, v116, 0
    v_mul_f32_e64 v118, v118, |v118|
    v_mul_f32_e64 v119, v119, |v119|
    v_mfma_f32_16x16x32_bf16 v[180:183], v[100:103], v[44:47], v[180:183]
    v_cvt_pk_bf16_f32 v117, v118, v119
    v_pk_max_i16 v117, v117, 0
    v_mul_f32_e64 v132, v132, |v132|
    v_mfma_f32_16x16x32_bf16 v[176:179], v[100:103], v[40:43], v[176:179]
    v_mul_f32_e64 v133, v133, |v133|
    v_cvt_pk_bf16_f32 v118, v132, v133
    v_pk_max_i16 v118, v118, 0
    v_mfma_f32_16x16x32_bf16 v[208:211], v[80:83], v[24:27], v[208:211]
    v_mul_f32_e64 v134, v134, |v134|
    v_mul_f32_e64 v135, v135, |v135|
    v_cvt_pk_bf16_f32 v119, v134, v135
    v_mfma_f32_16x16x32_bf16 v[212:215], v[80:83], v[28:31], v[212:215]
    v_pk_max_i16 v119, v119, 0
    buffer_store_dwordx4 v[116:119], v14, s[24:27], 0 offen offset:1024 sc1
    ds_write_b128 v19, v[116:119] offset:1024
    v_mfma_f32_16x16x32_bf16 v[216:219], v[80:83], v[32:35], v[216:219]
    v_mul_f32_e64 v112, v112, |v112|
    v_mul_f32_e64 v113, v113, |v113|
    v_cvt_pk_bf16_f32 v112, v112, v113
    v_mfma_f32_16x16x32_bf16 v[220:223], v[80:83], v[36:39], v[220:223]
    v_pk_max_i16 v112, v112, 0
    v_mul_f32_e64 v114, v114, |v114|
    v_mul_f32_e64 v115, v115, |v115|
    v_mfma_f32_16x16x32_bf16 v[204:207], v[104:107], v[52:55], v[204:207]
    v_cvt_pk_bf16_f32 v113, v114, v115
    v_pk_max_i16 v113, v113, 0
    v_mul_f32_e64 v128, v128, |v128|
    v_mfma_f32_16x16x32_bf16 v[200:203], v[104:107], v[48:51], v[200:203]
    v_mul_f32_e64 v129, v129, |v129|
    v_cvt_pk_bf16_f32 v114, v128, v129
    v_pk_max_i16 v114, v114, 0
    v_mfma_f32_16x16x32_bf16 v[196:199], v[104:107], v[44:47], v[196:199]
    v_mul_f32_e64 v130, v130, |v130|
    v_mul_f32_e64 v131, v131, |v131|
    v_cvt_pk_bf16_f32 v115, v130, v131
    v_mfma_f32_16x16x32_bf16 v[192:195], v[104:107], v[40:43], v[192:195]
    v_pk_max_i16 v115, v115, 0
    buffer_store_dwordx4 v[112:115], v14, s[24:27], 0 offen offset:0 sc1
    ds_write_b128 v19, v[112:115] offset:0
    v_mfma_f32_16x16x32_bf16 v[208:211], v[108:111], v[40:43], v[208:211]
    v_mul_f32_e64 v156, v156, |v156|
    v_mul_f32_e64 v157, v157, |v157|
    v_cvt_pk_bf16_f32 v156, v156, v157
    v_mfma_f32_16x16x32_bf16 v[212:215], v[108:111], v[44:47], v[212:215]
    v_pk_max_i16 v156, v156, 0
    v_mul_f32_e64 v158, v158, |v158|
    v_mul_f32_e64 v159, v159, |v159|
    v_mfma_f32_16x16x32_bf16 v[216:219], v[108:111], v[48:51], v[216:219]
    v_cvt_pk_bf16_f32 v157, v158, v159
    v_pk_max_i16 v157, v157, 0
    v_mul_f32_e64 v172, v172, |v172|
    v_mfma_f32_16x16x32_bf16 v[220:223], v[108:111], v[52:55], v[220:223]
    v_mul_f32_e64 v173, v173, |v173|
    v_cvt_pk_bf16_f32 v158, v172, v173
    v_pk_max_i16 v158, v158, 0
    v_mul_f32_e64 v174, v174, |v174|
    v_mul_f32_e64 v175, v175, |v175|
    v_cvt_pk_bf16_f32 v159, v174, v175
    v_pk_max_i16 v159, v159, 0
    buffer_store_dwordx4 v[156:159], v14, s[24:27], s54 offen offset:3072 sc1
    ds_write_b128 v19, v[156:159] offset:11264
    v_mul_f32_e64 v152, v152, |v152|
    v_mul_f32_e64 v153, v153, |v153|
    v_cvt_pk_bf16_f32 v152, v152, v153
    v_pk_max_i16 v152, v152, 0
    v_mul_f32_e64 v154, v154, |v154|
    v_mul_f32_e64 v155, v155, |v155|
    v_cvt_pk_bf16_f32 v153, v154, v155
    v_pk_max_i16 v153, v153, 0
    v_mul_f32_e64 v168, v168, |v168|
    v_mul_f32_e64 v169, v169, |v169|
    v_cvt_pk_bf16_f32 v154, v168, v169
    v_pk_max_i16 v154, v154, 0
    v_mul_f32_e64 v170, v170, |v170|
    v_mul_f32_e64 v171, v171, |v171|
    v_cvt_pk_bf16_f32 v155, v170, v171
    v_pk_max_i16 v155, v155, 0
    buffer_store_dwordx4 v[152:155], v14, s[24:27], s54 offen offset:2048 sc1
    ds_write_b128 v19, v[152:155] offset:10240
    v_mul_f32_e64 v148, v148, |v148|
    v_mul_f32_e64 v149, v149, |v149|
    v_cvt_pk_bf16_f32 v148, v148, v149
    v_pk_max_i16 v148, v148, 0
    v_mul_f32_e64 v150, v150, |v150|
    v_mul_f32_e64 v151, v151, |v151|
    v_cvt_pk_bf16_f32 v149, v150, v151
    v_pk_max_i16 v149, v149, 0
    v_mul_f32_e64 v164, v164, |v164|
    v_mul_f32_e64 v165, v165, |v165|
    v_cvt_pk_bf16_f32 v150, v164, v165
    v_pk_max_i16 v150, v150, 0
    v_mul_f32_e64 v166, v166, |v166|
    v_mul_f32_e64 v167, v167, |v167|
    v_cvt_pk_bf16_f32 v151, v166, v167
    v_pk_max_i16 v151, v151, 0
    buffer_store_dwordx4 v[148:151], v14, s[24:27], s54 offen offset:1024 sc1
    ds_write_b128 v19, v[148:151] offset:9216
    v_mul_f32_e64 v144, v144, |v144|
    v_mul_f32_e64 v145, v145, |v145|
    v_cvt_pk_bf16_f32 v144, v144, v145
    v_pk_max_i16 v144, v144, 0
    v_mul_f32_e64 v146, v146, |v146|
    v_mul_f32_e64 v147, v147, |v147|
    v_cvt_pk_bf16_f32 v145, v146, v147
    v_pk_max_i16 v145, v145, 0
    v_mul_f32_e64 v160, v160, |v160|
    v_mul_f32_e64 v161, v161, |v161|
    v_cvt_pk_bf16_f32 v146, v160, v161
    v_pk_max_i16 v146, v146, 0
    v_mul_f32_e64 v162, v162, |v162|
    v_mul_f32_e64 v163, v163, |v163|
    v_cvt_pk_bf16_f32 v147, v162, v163
    v_pk_max_i16 v147, v147, 0
    buffer_store_dwordx4 v[144:147], v14, s[24:27], s54 offen offset:0 sc1
    ds_write_b128 v19, v[144:147] offset:8192
    v_mul_f32_e64 v188, v188, |v188|
    v_mul_f32_e64 v189, v189, |v189|
    v_cvt_pk_bf16_f32 v188, v188, v189
    v_pk_max_i16 v188, v188, 0
    v_mul_f32_e64 v190, v190, |v190|
    v_mul_f32_e64 v191, v191, |v191|
    v_cvt_pk_bf16_f32 v189, v190, v191
    v_pk_max_i16 v189, v189, 0
    v_mul_f32_e64 v204, v204, |v204|
    v_mul_f32_e64 v205, v205, |v205|
    v_cvt_pk_bf16_f32 v190, v204, v205
    v_pk_max_i16 v190, v190, 0
    v_mul_f32_e64 v206, v206, |v206|
    v_mul_f32_e64 v207, v207, |v207|
    v_cvt_pk_bf16_f32 v191, v206, v207
    v_pk_max_i16 v191, v191, 0
    buffer_store_dwordx4 v[188:191], v14, s[24:27], s55 offen offset:3072 sc1
    ds_write_b128 v19, v[188:191] offset:19456
    v_mul_f32_e64 v184, v184, |v184|
    v_mul_f32_e64 v185, v185, |v185|
    v_cvt_pk_bf16_f32 v184, v184, v185
    v_pk_max_i16 v184, v184, 0
    v_mul_f32_e64 v186, v186, |v186|
    v_mul_f32_e64 v187, v187, |v187|
    v_cvt_pk_bf16_f32 v185, v186, v187
    v_pk_max_i16 v185, v185, 0
    v_mul_f32_e64 v200, v200, |v200|
    v_mul_f32_e64 v201, v201, |v201|
    v_cvt_pk_bf16_f32 v186, v200, v201
    v_pk_max_i16 v186, v186, 0
    v_mul_f32_e64 v202, v202, |v202|
    v_mul_f32_e64 v203, v203, |v203|
    v_cvt_pk_bf16_f32 v187, v202, v203
    v_pk_max_i16 v187, v187, 0
    buffer_store_dwordx4 v[184:187], v14, s[24:27], s55 offen offset:2048 sc1
    ds_write_b128 v19, v[184:187] offset:18432
    v_mul_f32_e64 v180, v180, |v180|
    v_mul_f32_e64 v181, v181, |v181|
    v_cvt_pk_bf16_f32 v180, v180, v181
    v_pk_max_i16 v180, v180, 0
    v_mul_f32_e64 v182, v182, |v182|
    v_mul_f32_e64 v183, v183, |v183|
    v_cvt_pk_bf16_f32 v181, v182, v183
    v_pk_max_i16 v181, v181, 0
    v_mul_f32_e64 v196, v196, |v196|
    v_mul_f32_e64 v197, v197, |v197|
    v_cvt_pk_bf16_f32 v182, v196, v197
    v_pk_max_i16 v182, v182, 0
    v_mul_f32_e64 v198, v198, |v198|
    v_mul_f32_e64 v199, v199, |v199|
    v_cvt_pk_bf16_f32 v183, v198, v199
    v_pk_max_i16 v183, v183, 0
    buffer_store_dwordx4 v[180:183], v14, s[24:27], s55 offen offset:1024 sc1
    ds_write_b128 v19, v[180:183] offset:17408
    v_mul_f32_e64 v176, v176, |v176|
    v_mul_f32_e64 v177, v177, |v177|
    v_cvt_pk_bf16_f32 v176, v176, v177
    v_pk_max_i16 v176, v176, 0
    v_mul_f32_e64 v178, v178, |v178|
    v_mul_f32_e64 v179, v179, |v179|
    v_cvt_pk_bf16_f32 v177, v178, v179
    v_pk_max_i16 v177, v177, 0
    v_mul_f32_e64 v192, v192, |v192|
    v_mul_f32_e64 v193, v193, |v193|
    v_cvt_pk_bf16_f32 v178, v192, v193
    v_pk_max_i16 v178, v178, 0
    v_mul_f32_e64 v194, v194, |v194|
    v_mul_f32_e64 v195, v195, |v195|
    v_cvt_pk_bf16_f32 v179, v194, v195
    v_pk_max_i16 v179, v179, 0
    buffer_store_dwordx4 v[176:179], v14, s[24:27], s55 offen offset:0 sc1
    ds_write_b128 v19, v[176:179] offset:16384
    v_mul_f32_e64 v208, v208, |v208|
    v_mul_f32_e64 v209, v209, |v209|
    v_cvt_pk_bf16_f32 v208, v208, v209
    v_pk_max_i16 v208, v208, 0
    v_mul_f32_e64 v210, v210, |v210|
    v_mul_f32_e64 v211, v211, |v211|
    v_cvt_pk_bf16_f32 v209, v210, v211
    v_pk_max_i16 v209, v209, 0
    ds_write_b64 v20, v[208:209] offset:0
    v_mul_f32_e64 v212, v212, |v212|
    v_mul_f32_e64 v213, v213, |v213|
    v_cvt_pk_bf16_f32 v212, v212, v213
    v_pk_max_i16 v212, v212, 0
    v_mul_f32_e64 v214, v214, |v214|
    v_mul_f32_e64 v215, v215, |v215|
    v_cvt_pk_bf16_f32 v213, v214, v215
    v_pk_max_i16 v213, v213, 0
    ds_write_b64 v20, v[212:213] offset:1024
    v_mul_f32_e64 v216, v216, |v216|
    v_mul_f32_e64 v217, v217, |v217|
    v_cvt_pk_bf16_f32 v216, v216, v217
    v_pk_max_i16 v216, v216, 0
    v_mul_f32_e64 v218, v218, |v218|
    v_mul_f32_e64 v219, v219, |v219|
    v_cvt_pk_bf16_f32 v217, v218, v219
    v_pk_max_i16 v217, v217, 0
    ds_write_b64 v20, v[216:217] offset:2048
    v_mul_f32_e64 v220, v220, |v220|
    v_mul_f32_e64 v221, v221, |v221|
    v_cvt_pk_bf16_f32 v220, v220, v221
    v_pk_max_i16 v220, v220, 0
    v_mul_f32_e64 v222, v222, |v222|
    v_mul_f32_e64 v223, v223, |v223|
    v_cvt_pk_bf16_f32 v221, v222, v223
    v_pk_max_i16 v221, v221, 0
    ds_write_b64 v20, v[220:221] offset:3072
    s_mov_b32 s57, 0
    s_waitcnt lgkmcnt(0)
    s_barrier
    ds_read_b128 v[104:107], v246
    ds_read_b128 v[108:111], v246 offset:1024
    ds_read_b64_tr_b16 v[192:193], v234 offset:0
    ds_read_b64_tr_b16 v[194:195], v234 offset:2048
    ds_read_b128 v[128:131], v232 offset:0
    ds_read_b128 v[132:135], v232 offset:1024
    ds_read_b128 v[136:139], v233 offset:0
    ds_read_b128 v[140:143], v233 offset:1024
    ds_read_b64_tr_b16 v[196:197], v235 offset:0
    ds_read_b64_tr_b16 v[198:199], v235 offset:2048
    ds_read_b64_tr_b16 v[200:201], v236 offset:0
    ds_read_b64_tr_b16 v[202:203], v236 offset:2048
    ds_read_b64_tr_b16 v[204:205], v237 offset:0
    ds_read_b64_tr_b16 v[206:207], v237 offset:2048
    buffer_load_dwordx2 v[244:245], v243, s[36:39], 0 offen sc1
    s_waitcnt lgkmcnt(12)
    buffer_store_dwordx4 v[104:107], v15, s[24:27], 0 offen sc1
    buffer_store_dwordx4 v[108:111], v15, s[24:27], 0 offen offset:1024 sc1
    s_waitcnt lgkmcnt(0)
    s_barrier
    v_mfma_f32_16x16x32_bf16 v[24:27], v[192:195], v[128:131], v[224:227]
    ds_read_b64_tr_b16 v[88:89], v234 offset:8192
    v_mfma_f32_16x16x32_bf16 v[40:43], v[192:195], v[132:135], v[224:227]
    ds_read_b64_tr_b16 v[90:91], v234 offset:10240
    v_mfma_f32_16x16x32_bf16 v[56:59], v[192:195], v[136:139], 0
    ds_read_b128 v[160:163], v232 offset:8192
    v_mfma_f32_16x16x32_bf16 v[72:75], v[192:195], v[140:143], 0
    ds_read_b128 v[164:167], v232 offset:9216
    v_mfma_f32_16x16x32_bf16 v[76:79], v[196:199], v[140:143], 0
    ds_read_b128 v[168:171], v233 offset:8192
    v_mfma_f32_16x16x32_bf16 v[60:63], v[196:199], v[136:139], 0
    ds_read_b128 v[172:175], v233 offset:9216
    v_mfma_f32_16x16x32_bf16 v[44:47], v[196:199], v[132:135], v[228:231]
    ds_read_b64_tr_b16 v[92:93], v235 offset:8192
    v_mfma_f32_16x16x32_bf16 v[28:31], v[196:199], v[128:131], v[228:231]
    ds_read_b64_tr_b16 v[94:95], v235 offset:10240
    v_mfma_f32_16x16x32_bf16 v[32:35], v[200:203], v[128:131], v[248:251]
    ds_read_b64_tr_b16 v[96:97], v236 offset:8192
    v_mfma_f32_16x16x32_bf16 v[48:51], v[200:203], v[132:135], v[248:251]
    ds_read_b64_tr_b16 v[98:99], v236 offset:10240
    v_mfma_f32_16x16x32_bf16 v[64:67], v[200:203], v[136:139], 0
    ds_read_b64_tr_b16 v[100:101], v237 offset:8192
    v_mfma_f32_16x16x32_bf16 v[80:83], v[200:203], v[140:143], 0
    ds_read_b64_tr_b16 v[102:103], v237 offset:10240
    v_mfma_f32_16x16x32_bf16 v[84:87], v[204:207], v[140:143], 0
    v_mfma_f32_16x16x32_bf16 v[68:71], v[204:207], v[136:139], 0
    v_mfma_f32_16x16x32_bf16 v[52:55], v[204:207], v[132:135], v[252:255]
    v_mfma_f32_16x16x32_bf16 v[36:39], v[204:207], v[128:131], v[252:255]
    s_branch C_g2a
.p2align 3
C_g2:
    s_waitcnt lgkmcnt(0)
    s_barrier
    v_mfma_f32_16x16x32_bf16 v[24:27], v[192:195], v[128:131], v[24:27]
    ds_read_b64_tr_b16 v[88:89], v234 offset:8192
    v_mfma_f32_16x16x32_bf16 v[40:43], v[192:195], v[132:135], v[40:43]
    ds_read_b64_tr_b16 v[90:91], v234 offset:10240
    v_mfma_f32_16x16x32_bf16 v[56:59], v[192:195], v[136:139], v[56:59]
    ds_read_b128 v[160:163], v232 offset:8192
    v_mfma_f32_16x16x32_bf16 v[72:75], v[192:195], v[140:143], v[72:75]
    ds_read_b128 v[164:167], v232 offset:9216
    v_mfma_f32_16x16x32_bf16 v[76:79], v[196:199], v[140:143], v[76:79]
    ds_read_b128 v[168:171], v233 offset:8192
    v_mfma_f32_16x16x32_bf16 v[60:63], v[196:199], v[136:139], v[60:63]
    ds_read_b128 v[172:175], v233 offset:9216
    v_mfma_f32_16x16x32_bf16 v[44:47], v[196:199], v[132:135], v[44:47]
    ds_read_b64_tr_b16 v[92:93], v235 offset:8192
    v_mfma_f32_16x16x32_bf16 v[28:31], v[196:199], v[128:131], v[28:31]
    ds_read_b64_tr_b16 v[94:95], v235 offset:10240
    v_mfma_f32_16x16x32_bf16 v[32:35], v[200:203], v[128:131], v[32:35]
    ds_read_b64_tr_b16 v[96:97], v236 offset:8192
    v_mfma_f32_16x16x32_bf16 v[48:51], v[200:203], v[132:135], v[48:51]
    ds_read_b64_tr_b16 v[98:99], v236 offset:10240
    v_mfma_f32_16x16x32_bf16 v[64:67], v[200:203], v[136:139], v[64:67]
    ds_read_b64_tr_b16 v[100:101], v237 offset:8192
    v_mfma_f32_16x16x32_bf16 v[80:83], v[200:203], v[140:143], v[80:83]
    ds_read_b64_tr_b16 v[102:103], v237 offset:10240
    v_mfma_f32_16x16x32_bf16 v[84:87], v[204:207], v[140:143], v[84:87]
    v_mfma_f32_16x16x32_bf16 v[68:71], v[204:207], v[136:139], v[68:71]
    v_mfma_f32_16x16x32_bf16 v[52:55], v[204:207], v[132:135], v[52:55]
    v_mfma_f32_16x16x32_bf16 v[36:39], v[204:207], v[128:131], v[36:39]
C_g2a:
    s_waitcnt lgkmcnt(0)
    v_mfma_f32_16x16x32_bf16 v[24:27], v[88:91], v[160:163], v[24:27]
    ds_read_b64_tr_b16 v[192:193], v234 offset:16384
    v_mfma_f32_16x16x32_bf16 v[40:43], v[88:91], v[164:167], v[40:43]
    ds_read_b64_tr_b16 v[194:195], v234 offset:18432
    v_mfma_f32_16x16x32_bf16 v[56:59], v[88:91], v[168:171], v[56:59]
    ds_read_b128 v[128:131], v232 offset:16384
    v_mfma_f32_16x16x32_bf16 v[72:75], v[88:91], v[172:175], v[72:75]
    ds_read_b128 v[132:135], v232 offset:17408
    v_mfma_f32_16x16x32_bf16 v[76:79], v[92:95], v[172:175], v[76:79]
    ds_read_b128 v[136:139], v233 offset:16384
    v_mfma_f32_16x16x32_bf16 v[60:63], v[92:95], v[168:171], v[60:63]
    ds_read_b128 v[140:143], v233 offset:17408
    v_mfma_f32_16x16x32_bf16 v[44:47], v[92:95], v[164:167], v[44:47]
    ds_read_b64_tr_b16 v[196:197], v235 offset:16384
    v_mfma_f32_16x16x32_bf16 v[28:31], v[92:95], v[160:163], v[28:31]
    ds_read_b64_tr_b16 v[198:199], v235 offset:18432
    v_mfma_f32_16x16x32_bf16 v[32:35], v[96:99], v[160:163], v[32:35]
    ds_read_b64_tr_b16 v[200:201], v236 offset:16384
    v_mfma_f32_16x16x32_bf16 v[48:51], v[96:99], v[164:167], v[48:51]
    ds_read_b64_tr_b16 v[202:203], v236 offset:18432
    v_mfma_f32_16x16x32_bf16 v[64:67], v[96:99], v[168:171], v[64:67]
    ds_read_b64_tr_b16 v[204:205], v237 offset:16384
    v_mfma_f32_16x16x32_bf16 v[80:83], v[96:99], v[172:175], v[80:83]
    ds_read_b64_tr_b16 v[206:207], v237 offset:18432
    v_mfma_f32_16x16x32_bf16 v[84:87], v[100:103], v[172:175], v[84:87]
    v_mfma_f32_16x16x32_bf16 v[68:71], v[100:103], v[168:171], v[68:71]
    v_mfma_f32_16x16x32_bf16 v[52:55], v[100:103], v[164:167], v[52:55]
    v_mfma_f32_16x16x32_bf16 v[36:39], v[100:103], v[160:163], v[36:39]
    s_waitcnt lgkmcnt(0)
    s_barrier
    v_mfma_f32_16x16x32_bf16 v[24:27], v[192:195], v[128:131], v[24:27]
    ds_read_b64_tr_b16 v[88:89], v234 offset:24576
    v_mfma_f32_16x16x32_bf16 v[40:43], v[192:195], v[132:135], v[40:43]
    ds_read_b64_tr_b16 v[90:91], v234 offset:26624
    v_mfma_f32_16x16x32_bf16 v[56:59], v[192:195], v[136:139], v[56:59]
    ds_read_b128 v[160:163], v232 offset:24576
    v_mfma_f32_16x16x32_bf16 v[72:75], v[192:195], v[140:143], v[72:75]
    ds_read_b128 v[164:167], v232 offset:25600
    v_mfma_f32_16x16x32_bf16 v[76:79], v[196:199], v[140:143], v[76:79]
    ds_read_b128 v[168:171], v233 offset:24576
    v_mfma_f32_16x16x32_bf16 v[60:63], v[196:199], v[136:139], v[60:63]
    ds_read_b128 v[172:175], v233 offset:25600
    v_mfma_f32_16x16x32_bf16 v[44:47], v[196:199], v[132:135], v[44:47]
    ds_read_b64_tr_b16 v[92:93], v235 offset:24576
    v_mfma_f32_16x16x32_bf16 v[28:31], v[196:199], v[128:131], v[28:31]
    ds_read_b64_tr_b16 v[94:95], v235 offset:26624
    v_mfma_f32_16x16x32_bf16 v[32:35], v[200:203], v[128:131], v[32:35]
    ds_read_b64_tr_b16 v[96:97], v236 offset:24576
    v_mfma_f32_16x16x32_bf16 v[48:51], v[200:203], v[132:135], v[48:51]
    ds_read_b64_tr_b16 v[98:99], v236 offset:26624
    v_mfma_f32_16x16x32_bf16 v[64:67], v[200:203], v[136:139], v[64:67]
    ds_read_b64_tr_b16 v[100:101], v237 offset:24576
    v_mfma_f32_16x16x32_bf16 v[80:83], v[200:203], v[140:143], v[80:83]
    ds_read_b64_tr_b16 v[102:103], v237 offset:26624
    v_mfma_f32_16x16x32_bf16 v[84:87], v[204:207], v[140:143], v[84:87]
    v_mfma_f32_16x16x32_bf16 v[68:71], v[204:207], v[136:139], v[68:71]
    v_mfma_f32_16x16x32_bf16 v[52:55], v[204:207], v[132:135], v[52:55]
    v_mfma_f32_16x16x32_bf16 v[36:39], v[204:207], v[128:131], v[36:39]
    s_waitcnt lgkmcnt(0)
    v_mfma_f32_16x16x32_bf16 v[24:27], v[88:91], v[160:163], v[24:27]
    ds_read_b64_tr_b16 v[192:193], v234 offset:32768
    v_mfma_f32_16x16x32_bf16 v[40:43], v[88:91], v[164:167], v[40:43]
    ds_read_b64_tr_b16 v[194:195], v234 offset:34816
    v_mfma_f32_16x16x32_bf16 v[56:59], v[88:91], v[168:171], v[56:59]
    ds_read_b128 v[128:131], v232 offset:32768
    v_mfma_f32_16x16x32_bf16 v[72:75], v[88:91], v[172:175], v[72:75]
    ds_read_b128 v[132:135], v232 offset:33792
    v_mfma_f32_16x16x32_bf16 v[76:79], v[92:95], v[172:175], v[76:79]
    ds_read_b128 v[136:139], v233 offset:32768
    v_mfma_f32_16x16x32_bf16 v[60:63], v[92:95], v[168:171], v[60:63]
    ds_read_b128 v[140:143], v233 offset:33792
    v_mfma_f32_16x16x32_bf16 v[44:47], v[92:95], v[164:167], v[44:47]
    ds_read_b64_tr_b16 v[196:197], v235 offset:32768
    v_mfma_f32_16x16x32_bf16 v[28:31], v[92:95], v[160:163], v[28:31]
    ds_read_b64_tr_b16 v[198:199], v235 offset:34816
    v_mfma_f32_16x16x32_bf16 v[32:35], v[96:99], v[160:163], v[32:35]
    ds_read_b64_tr_b16 v[200:201], v236 offset:32768
    v_mfma_f32_16x16x32_bf16 v[48:51], v[96:99], v[164:167], v[48:51]
    ds_read_b64_tr_b16 v[202:203], v236 offset:34816
    v_mfma_f32_16x16x32_bf16 v[64:67], v[96:99], v[168:171], v[64:67]
    ds_read_b64_tr_b16 v[204:205], v237 offset:32768
    v_mfma_f32_16x16x32_bf16 v[80:83], v[96:99], v[172:175], v[80:83]
    ds_read_b64_tr_b16 v[206:207], v237 offset:34816
    v_mfma_f32_16x16x32_bf16 v[84:87], v[100:103], v[172:175], v[84:87]
    v_mfma_f32_16x16x32_bf16 v[68:71], v[100:103], v[168:171], v[68:71]
    v_mfma_f32_16x16x32_bf16 v[52:55], v[100:103], v[164:167], v[52:55]
    v_mfma_f32_16x16x32_bf16 v[36:39], v[100:103], v[160:163], v[36:39]
    s_waitcnt vmcnt(0) lgkmcnt(0)
    s_barrier
    v_mfma_f32_16x16x32_bf16 v[24:27], v[192:195], v[128:131], v[24:27]
    ds_read_b64_tr_b16 v[88:89], v234 offset:40960
    v_mfma_f32_16x16x32_bf16 v[40:43], v[192:195], v[132:135], v[40:43]
    ds_read_b64_tr_b16 v[90:91], v234 offset:43008
    v_mfma_f32_16x16x32_bf16 v[56:59], v[192:195], v[136:139], v[56:59]
    ds_read_b128 v[160:163], v232 offset:40960
    v_mfma_f32_16x16x32_bf16 v[72:75], v[192:195], v[140:143], v[72:75]
    ds_read_b128 v[164:167], v232 offset:41984
    v_mfma_f32_16x16x32_bf16 v[76:79], v[196:199], v[140:143], v[76:79]
    ds_read_b128 v[168:171], v233 offset:40960
    v_mfma_f32_16x16x32_bf16 v[60:63], v[196:199], v[136:139], v[60:63]
    ds_read_b128 v[172:175], v233 offset:41984
    v_mfma_f32_16x16x32_bf16 v[44:47], v[196:199], v[132:135], v[44:47]
    ds_read_b64_tr_b16 v[92:93], v235 offset:40960
    v_mfma_f32_16x16x32_bf16 v[28:31], v[196:199], v[128:131], v[28:31]
    ds_read_b64_tr_b16 v[94:95], v235 offset:43008
    v_mfma_f32_16x16x32_bf16 v[32:35], v[200:203], v[128:131], v[32:35]
    ds_read_b64_tr_b16 v[96:97], v236 offset:40960
    v_mfma_f32_16x16x32_bf16 v[48:51], v[200:203], v[132:135], v[48:51]
    ds_read_b64_tr_b16 v[98:99], v236 offset:43008
    v_mfma_f32_16x16x32_bf16 v[64:67], v[200:203], v[136:139], v[64:67]
    ds_read_b64_tr_b16 v[100:101], v237 offset:40960
    v_mfma_f32_16x16x32_bf16 v[80:83], v[200:203], v[140:143], v[80:83]
    ds_read_b64_tr_b16 v[102:103], v237 offset:43008
    v_mfma_f32_16x16x32_bf16 v[84:87], v[204:207], v[140:143], v[84:87]
    v_mfma_f32_16x16x32_bf16 v[68:71], v[204:207], v[136:139], v[68:71]
    v_mfma_f32_16x16x32_bf16 v[52:55], v[204:207], v[132:135], v[52:55]
    v_mfma_f32_16x16x32_bf16 v[36:39], v[204:207], v[128:131], v[36:39]
    s_waitcnt lgkmcnt(0)
    v_mfma_f32_16x16x32_bf16 v[24:27], v[88:91], v[160:163], v[24:27]
    ds_read_b64_tr_b16 v[192:193], v234 offset:49152
    v_mfma_f32_16x16x32_bf16 v[40:43], v[88:91], v[164:167], v[40:43]
    ds_read_b64_tr_b16 v[194:195], v234 offset:51200
    v_mfma_f32_16x16x32_bf16 v[56:59], v[88:91], v[168:171], v[56:59]
    ds_read_b128 v[128:131], v232 offset:49152
    v_mfma_f32_16x16x32_bf16 v[72:75], v[88:91], v[172:175], v[72:75]
    ds_read_b128 v[132:135], v232 offset:50176
    v_mfma_f32_16x16x32_bf16 v[76:79], v[92:95], v[172:175], v[76:79]
    ds_read_b128 v[136:139], v233 offset:49152
    v_mfma_f32_16x16x32_bf16 v[60:63], v[92:95], v[168:171], v[60:63]
    ds_read_b128 v[140:143], v233 offset:50176
    v_mfma_f32_16x16x32_bf16 v[44:47], v[92:95], v[164:167], v[44:47]
    ds_read_b64_tr_b16 v[196:197], v235 offset:49152
    v_mfma_f32_16x16x32_bf16 v[28:31], v[92:95], v[160:163], v[28:31]
    ds_read_b64_tr_b16 v[198:199], v235 offset:51200
    v_mfma_f32_16x16x32_bf16 v[32:35], v[96:99], v[160:163], v[32:35]
    ds_read_b64_tr_b16 v[200:201], v236 offset:49152
    v_mfma_f32_16x16x32_bf16 v[48:51], v[96:99], v[164:167], v[48:51]
    ds_read_b64_tr_b16 v[202:203], v236 offset:51200
    v_mfma_f32_16x16x32_bf16 v[64:67], v[96:99], v[168:171], v[64:67]
    ds_read_b64_tr_b16 v[204:205], v237 offset:49152
    v_mfma_f32_16x16x32_bf16 v[80:83], v[96:99], v[172:175], v[80:83]
    ds_read_b64_tr_b16 v[206:207], v237 offset:51200
    v_mfma_f32_16x16x32_bf16 v[84:87], v[100:103], v[172:175], v[84:87]
    v_mfma_f32_16x16x32_bf16 v[68:71], v[100:103], v[168:171], v[68:71]
    v_mfma_f32_16x16x32_bf16 v[52:55], v[100:103], v[164:167], v[52:55]
    v_mfma_f32_16x16x32_bf16 v[36:39], v[100:103], v[160:163], v[36:39]
    s_waitcnt lgkmcnt(0)
    s_barrier
    v_mfma_f32_16x16x32_bf16 v[24:27], v[192:195], v[128:131], v[24:27]
    ds_read_b64_tr_b16 v[88:89], v234 offset:57344
    v_mfma_f32_16x16x32_bf16 v[40:43], v[192:195], v[132:135], v[40:43]
    ds_read_b64_tr_b16 v[90:91], v234 offset:59392
    v_mfma_f32_16x16x32_bf16 v[56:59], v[192:195], v[136:139], v[56:59]
    ds_read_b128 v[160:163], v232 offset:57344
    v_mfma_f32_16x16x32_bf16 v[72:75], v[192:195], v[140:143], v[72:75]
    ds_read_b128 v[164:167], v232 offset:58368
    v_mfma_f32_16x16x32_bf16 v[76:79], v[196:199], v[140:143], v[76:79]
    ds_read_b128 v[168:171], v233 offset:57344
    v_mfma_f32_16x16x32_bf16 v[60:63], v[196:199], v[136:139], v[60:63]
    ds_read_b128 v[172:175], v233 offset:58368
    v_mfma_f32_16x16x32_bf16 v[44:47], v[196:199], v[132:135], v[44:47]
    ds_read_b64_tr_b16 v[92:93], v235 offset:57344
    v_mfma_f32_16x16x32_bf16 v[28:31], v[196:199], v[128:131], v[28:31]
    ds_read_b64_tr_b16 v[94:95], v235 offset:59392
    v_mfma_f32_16x16x32_bf16 v[32:35], v[200:203], v[128:131], v[32:35]
    ds_read_b64_tr_b16 v[96:97], v236 offset:57344
    v_mfma_f32_16x16x32_bf16 v[48:51], v[200:203], v[132:135], v[48:51]
    ds_read_b64_tr_b16 v[98:99], v236 offset:59392
    v_mfma_f32_16x16x32_bf16 v[64:67], v[200:203], v[136:139], v[64:67]
    ds_read_b64_tr_b16 v[100:101], v237 offset:57344
    v_mfma_f32_16x16x32_bf16 v[80:83], v[200:203], v[140:143], v[80:83]
    ds_read_b64_tr_b16 v[102:103], v237 offset:59392
    v_mfma_f32_16x16x32_bf16 v[84:87], v[204:207], v[140:143], v[84:87]
    v_mfma_f32_16x16x32_bf16 v[68:71], v[204:207], v[136:139], v[68:71]
    v_mfma_f32_16x16x32_bf16 v[52:55], v[204:207], v[132:135], v[52:55]
    v_mfma_f32_16x16x32_bf16 v[36:39], v[204:207], v[128:131], v[36:39]
    s_waitcnt lgkmcnt(0)
    v_mfma_f32_16x16x32_bf16 v[24:27], v[88:91], v[160:163], v[24:27]
    ds_read_b64_tr_b16 v[192:193], v234 offset:0
    v_mfma_f32_16x16x32_bf16 v[40:43], v[88:91], v[164:167], v[40:43]
    ds_read_b64_tr_b16 v[194:195], v234 offset:2048
    v_mfma_f32_16x16x32_bf16 v[56:59], v[88:91], v[168:171], v[56:59]
    ds_read_b128 v[128:131], v232 offset:0
    v_mfma_f32_16x16x32_bf16 v[72:75], v[88:91], v[172:175], v[72:75]
    ds_read_b128 v[132:135], v232 offset:1024
    v_mfma_f32_16x16x32_bf16 v[76:79], v[92:95], v[172:175], v[76:79]
    ds_read_b128 v[136:139], v233 offset:0
    v_mfma_f32_16x16x32_bf16 v[60:63], v[92:95], v[168:171], v[60:63]
    ds_read_b128 v[140:143], v233 offset:1024
    v_mfma_f32_16x16x32_bf16 v[44:47], v[92:95], v[164:167], v[44:47]
    ds_read_b64_tr_b16 v[196:197], v235 offset:0
    v_mfma_f32_16x16x32_bf16 v[28:31], v[92:95], v[160:163], v[28:31]
    ds_read_b64_tr_b16 v[198:199], v235 offset:2048
    v_mfma_f32_16x16x32_bf16 v[32:35], v[96:99], v[160:163], v[32:35]
    ds_read_b64_tr_b16 v[200:201], v236 offset:0
    v_mfma_f32_16x16x32_bf16 v[48:51], v[96:99], v[164:167], v[48:51]
    ds_read_b64_tr_b16 v[202:203], v236 offset:2048
    v_mfma_f32_16x16x32_bf16 v[64:67], v[96:99], v[168:171], v[64:67]
    ds_read_b64_tr_b16 v[204:205], v237 offset:0
    v_mfma_f32_16x16x32_bf16 v[80:83], v[96:99], v[172:175], v[80:83]
    ds_read_b64_tr_b16 v[206:207], v237 offset:2048
    v_mfma_f32_16x16x32_bf16 v[84:87], v[100:103], v[172:175], v[84:87]
    s_add_u32 s57, s57, 1
    s_cmp_lt_u32 s57, 7
    v_mfma_f32_16x16x32_bf16 v[68:71], v[100:103], v[168:171], v[68:71]
    v_mfma_f32_16x16x32_bf16 v[52:55], v[100:103], v[164:167], v[52:55]
    v_mfma_f32_16x16x32_bf16 v[36:39], v[100:103], v[160:163], v[36:39]
    s_cbranch_scc1 C_g2
    s_nop 7
    buffer_store_dwordx4 v[56:59], v238, s[24:27], 0 offen offset:0 sc1
    buffer_store_dwordx4 v[72:75], v238, s[24:27], s59 offen offset:0 sc1
    buffer_store_dwordx4 v[60:63], v238, s[24:27], 0 offen offset:1024 sc1
    buffer_store_dwordx4 v[76:79], v238, s[24:27], s59 offen offset:1024 sc1
    buffer_store_dwordx4 v[64:67], v238, s[24:27], 0 offen offset:2048 sc1
    buffer_store_dwordx4 v[80:83], v238, s[24:27], s59 offen offset:2048 sc1
    buffer_store_dwordx4 v[68:71], v238, s[24:27], 0 offen offset:3072 sc1
    buffer_store_dwordx4 v[84:87], v238, s[24:27], s59 offen offset:3072 sc1
    s_mov_b64 exec, 0xff
    s_mov_b32 s61, 0x100000
    s_waitcnt vmcnt(0) lgkmcnt(0)
    buffer_store_dwordx4 v[244:247], v242, s[44:47], 0 offen sc1
    s_mov_b64 exec, 1
C_poll:
    s_sub_u32 s61, s61, 1
    s_cbranch_scc1 C_go
    buffer_load_dwordx2 v[4:5], v241, s[44:47], 0 offen sc1
    s_waitcnt vmcnt(0)
    v_cmp_eq_u64 vcc, v[4:5], v[244:245]
    s_nop 1
    s_cmp_eq_u32 vcc_lo, 1
    s_cbranch_scc0 C_poll
C_go:
    s_mov_b64 exec, -1
    buffer_load_dwordx4 v[56:59], v239, s[24:27], 0 offen offset:0 sc1
    buffer_load_dwordx4 v[60:63], v239, s[24:27], 0 offen offset:1024 sc1
    buffer_load_dwordx4 v[64:67], v239, s[24:27], 0 offen offset:2048 sc1
    buffer_load_dwordx4 v[68:71], v239, s[24:27], 0 offen offset:3072 sc1
    buffer_load_dwordx4 v[72:75], v239, s[24:27], s59 offen offset:0 sc1
    buffer_load_dwordx4 v[76:79], v239, s[24:27], s59 offen offset:1024 sc1
    buffer_load_dwordx4 v[80:83], v239, s[24:27], s59 offen offset:2048 sc1
    buffer_load_dwordx4 v[84:87], v239, s[24:27], s59 offen offset:3072 sc1
    s_waitcnt vmcnt(7)
    v_pk_add_f32 v[24:25], v[24:25], v[56:57]
    v_pk_add_f32 v[26:27], v[26:27], v[58:59]
    v_cvt_pk_bf16_f32 v112, v24, v25
    v_cvt_pk_bf16_f32 v113, v26, v27
    s_waitcnt vmcnt(6)
    v_pk_add_f32 v[28:29], v[28:29], v[60:61]
    v_pk_add_f32 v[30:31], v[30:31], v[62:63]
    v_cvt_pk_bf16_f32 v114, v28, v29
    v_cvt_pk_bf16_f32 v115, v30, v31
    s_nop 1
    v_permlane16_swap_b32 v112, v114
    v_permlane16_swap_b32 v113, v115
    s_waitcnt vmcnt(5)
    v_pk_add_f32 v[32:33], v[32:33], v[64:65]
    v_pk_add_f32 v[34:35], v[34:35], v[66:67]
    v_cvt_pk_bf16_f32 v116, v32, v33
    v_cvt_pk_bf16_f32 v117, v34, v35
    s_waitcnt vmcnt(4)
    v_pk_add_f32 v[36:37], v[36:37], v[68:69]
    v_pk_add_f32 v[38:39], v[38:39], v[70:71]
    v_cvt_pk_bf16_f32 v118, v36, v37
    v_cvt_pk_bf16_f32 v119, v38, v39
    s_nop 1
    v_permlane16_swap_b32 v116, v118
    v_permlane16_swap_b32 v117, v119
    s_waitcnt vmcnt(3)
    v_pk_add_f32 v[40:41], v[40:41], v[72:73]
    v_pk_add_f32 v[42:43], v[42:43], v[74:75]
    v_cvt_pk_bf16_f32 v120, v40, v41
    v_cvt_pk_bf16_f32 v121, v42, v43
    s_waitcnt vmcnt(2)
    v_pk_add_f32 v[44:45], v[44:45], v[76:77]
    v_pk_add_f32 v[46:47], v[46:47], v[78:79]
    v_cvt_pk_bf16_f32 v122, v44, v45
    v_cvt_pk_bf16_f32 v123, v46, v47
    s_nop 1
    v_permlane16_swap_b32 v120, v122
    v_permlane16_swap_b32 v121, v123
    s_waitcnt vmcnt(1)
    v_pk_add_f32 v[48:49], v[48:49], v[80:81]
    v_pk_add_f32 v[50:51], v[50:51], v[82:83]
    v_cvt_pk_bf16_f32 v124, v48, v49
    v_cvt_pk_bf16_f32 v125, v50, v51
    s_waitcnt vmcnt(0)
    v_pk_add_f32 v[52:53], v[52:53], v[84:85]
    v_pk_add_f32 v[54:55], v[54:55], v[86:87]
    v_cvt_pk_bf16_f32 v126, v52, v53
    v_cvt_pk_bf16_f32 v127, v54, v55
    s_nop 1
    v_permlane16_swap_b32 v124, v126
    v_permlane16_swap_b32 v125, v127
    s_nop 1
    buffer_store_dwordx4 v[112:115], v240, s[32:35], 0 offen offset:0
    buffer_store_dwordx4 v[116:119], v240, s[32:35], 0 offen offset:64
    buffer_store_dwordx4 v[120:123], v240, s[32:35], s60 offen offset:0
    buffer_store_dwordx4 v[124:127], v240, s[32:35], s60 offen offset:64
L_end:
    s_endpgm
.section .rodata,"a"
.p2align 6
.amdhsa_kernel standalone__dense_activation_squared_relu__prompt_kernel
  .amdhsa_next_free_vgpr 256
  .amdhsa_next_free_sgpr 102
  .amdhsa_accum_offset 256
  .amdhsa_group_segment_fixed_size 0
  .amdhsa_kernarg_size 64
  .amdhsa_user_sgpr_count 2
  .amdhsa_user_sgpr_kernarg_segment_ptr 1
  .amdhsa_system_sgpr_workgroup_id_x 1
.end_amdhsa_kernel
```
